```python
import torch

def _softmax(x, axis=-1):
    return torch.softmax(x, dim=axis)
def _gelu(x):
    return torch.nn.functional.gelu(x, approximate="tanh")
def _silu(x):
    return torch.nn.functional.silu(x)
def _sigmoid(x):
    return torch.sigmoid(x)
def _layernorm(x, axis=-1, eps=1e-5):
    m = x.mean(dim=axis, keepdim=True)
    v = x.var(dim=axis, keepdim=True, unbiased=False)
    return (x - m) / torch.sqrt(v + eps)
def _scatter_add(tgt, idx, src, axis=0):
    return tgt.clone().index_add_(axis, idx, src)
def _segment_sum(src, seg, n):
    out = torch.zeros((n,) + src.shape[1:], dtype=src.dtype)
    return out.index_add_(0, seg, src)
def _pad(x, pw):
    flat = tuple(v for pair in reversed(pw) for v in pair)
    return torch.nn.functional.pad(x, flat)

kernel_name = 'standalone__fused_io_aware_attn__prompt'

def setup_inputs():

    _w = (lambda a: (lambda t: t.to(torch.bfloat16) if t.is_floating_point() else t)(torch.as_tensor(a)))
    B, H, S = 1, 32, 2048
    Dh = max(1, 576 // 32)
    return {
        "q": _w((lambda *s: torch.randn(*s, dtype=torch.bfloat16) * 0.8)(B, H, S, Dh)),
        "k": _w((lambda *s: torch.randn(*s, dtype=torch.bfloat16) * 0.8)(B, H, S, Dh)),
        "v": _w((lambda *s: torch.randn(*s, dtype=torch.bfloat16) * 0.05)(B, H, S, Dh)),
    }

def reference(q, k, v):
    scale = q.shape[-1] ** -0.5
    s = torch.einsum('bhqd,bhkd->bhqk', q, k) * scale
    p = _softmax(s, axis=-1)
    return torch.einsum('bhqk,bhkd->bhqd', p, v)
```

```asm
; @launch grid=(256,1,1) block=(640,1,1) lds=163840
.amdgcn_target "amdgcn-amd-amdhsa--gfx950"
.text
.globl standalone__fused_io_aware_attn__prompt_kernel
.p2align 8
.type standalone__fused_io_aware_attn__prompt_kernel,@function
standalone__fused_io_aware_attn__prompt_kernel:
    s_cmp_ge_u32 s2, 256
    s_cbranch_scc1 L_end
    s_load_dwordx4 s[4:7], s[0:1], 0
    s_load_dwordx4 s[28:31], s[0:1], 16
    s_mov_b32 s46, 0
    v_lshrrev_b32 v1, 6, v0
    v_and_b32 v2, 63, v0
    v_readfirstlane_b32 s24, v1
    s_and_b32 s25, s2, 7
    s_lshl_b32 s25, s25, 2
    s_bfe_u32 s26, s2, 0x20003
    s_add_u32 s25, s25, s26
    s_mul_i32 s27, s25, 73728
    s_lshr_b32 s26, s2, 5
    s_mul_i32 s26, s26, 9216
    s_mul_i32 s35, s24, 1152
    s_add_u32 s26, s26, s35
    v_and_b32 v3, 31, v2
    v_lshrrev_b32 v4, 5, v2
    v_mul_u32_u24 v13, 36, v3
    v_add_u32 v13, s26, v13
    v_lshlrev_b32 v5, 4, v4
    v_add_u32 v162, v13, v5
    v_and_b32 v7, 15, v2
    v_lshlrev_b32 v7, 1, v7
    v_bfe_u32 v14, v2, 4, 1
    v_add_u32 v7, v7, v14
    v_mul_u32_u24 v7, 36, v7
    v_add_u32 v152, v7, v5
    v_mul_u32_u24 v15, 0x480, v4
    v_add3_u32 v153, v7, v15, 32
    v_lshlrev_b32 v154, 4, v2
    s_lshl_b32 s34, s24, 10
    s_lshl_b32 s36, s24, 8
    s_add_u32 s36, s36, 65536
    s_mul_i32 s37, s24, 2304
    s_add_u32 s38, s34, 152576
    s_cmp_ge_u32 s24, 5
    s_cselect_b32 s39, 0x400, 0
    s_sub_u32 s39, s34, s39
    s_mov_b32 s18, 73728
    s_mov_b32 s19, 0x20000
    s_mov_b32 s10, 73728
    s_mov_b32 s11, 0x20000
    s_mov_b32 s14, 73728
    s_mov_b32 s15, 0x20000
    s_mov_b32 s22, 73728
    s_mov_b32 s23, 0x20000
    s_cmp_ge_u32 s24, 8
    s_cbranch_scc1 L_loader
    s_waitcnt lgkmcnt(0)
    s_add_u32 s8, s6, s27
    s_addc_u32 s9, s7, 0
    s_add_u32 m0, s34, 0
    s_add_u32 s32, s35, 0
    buffer_load_dwordx4 v152, s[8:11], s32 offen lds
    s_add_u32 s12, s28, s27
    s_addc_u32 s13, s29, 0
    s_add_u32 m0, s38, 0
    s_add_u32 s32, s39, 0
    buffer_load_dwordx4 v154, s[12:15], s32 offen lds
    s_cmp_ge_u32 s24, 4
    s_cbranch_scc1 L_k2x
    s_add_u32 m0, s36, 0
    s_add_u32 s32, s37, 0
    buffer_load_dword v153, s[8:11], s32 offen lds
    s_branch L_k2a
L_k2x:
    s_cmp_lt_u32 s24, 6
    s_cbranch_scc1 L_k2a
    s_add_u32 m0, s38, 2048
    s_add_u32 s32, s34, 1024
    buffer_load_dwordx4 v154, s[12:15], s32 offen lds
L_k2a:
    s_add_u32 s16, s4, s27
    s_addc_u32 s17, s5, 0
    buffer_load_dwordx4 v[16:19], v162, s[16:19], 0 offen
    buffer_load_dword v20, v13, s[16:19], 0 offen offset:32
    s_add_u32 s20, s30, s27
    s_addc_u32 s21, s31, 0
    v_and_b32 v1, 1, v2
    v_mov_b32 v25, 0x3f803f80
    v_cmp_eq_u32 vcc, 0, v1
    v_lshlrev_b32 v1, 4, v0
    v_add_u32 v1, 147744, v1
    v_cndmask_b32 v24, 0, v25, vcc
    v_cmp_gt_u32 vcc, 272, v0
    v_mov_b32 v25, v24
    v_mov_b32 v26, v24
    v_mov_b32 v27, v24
    s_and_saveexec_b64 s[40:41], vcc
    ds_write_b128 v1, v[24:27]
    s_mov_b64 exec, s[40:41]
    v_lshlrev_b32 v8, 4, v2
    v_lshlrev_b32 v9, 2, v2
    v_add_u32 v9, 65536, v9
    v_and_b32 v3, 31, v2
    v_mov_b32 v6, 147920
    v_add_u32 v1, -20, v3
    v_mov_b32 v7, 147792
    v_cmp_gt_u32 vcc, 8, v1
    v_mul_u32_u24 v10, 4112, v3
    v_or_b32 v1, 4, v3
    v_cndmask_b32 v6, v6, v7, vcc
    v_cmp_eq_u32 vcc, 28, v1
    v_lshl_add_u32 v10, v4, 4, v10
    v_add_u32 v7, 16, v6
    v_cndmask_b32 v6, v6, v7, vcc
    v_cmp_gt_u32 vcc, 18, v3
    v_add_u32 v10, 73728, v10
    s_nop 0
    v_cndmask_b32 v10, v6, v10, vcc
    v_mov_b32 v158, v10
    v_mov_b32 v21, 0
    v_mov_b32 v23, 0
    v_mov_b32 v163, 163836
    v_lshl_add_u32 v5, v4, 4, v13
    s_mov_b32 s44, 0
    s_mov_b32 s45, -1
    s_mov_b32 s33, 0x3eae1a93
    v_mov_b32 v48, 0xdddddddd
    v_mov_b32 v56, 0
    v_mov_b32 v57, 0
    v_mov_b32 v58, 0
    v_mov_b32 v59, 0
    v_mov_b32 v60, 0
    v_mov_b32 v61, 0
    v_mov_b32 v62, 0
    v_mov_b32 v63, 0
    v_mov_b32 v64, 0
    v_mov_b32 v65, 0
    v_mov_b32 v66, 0
    v_mov_b32 v67, 0
    v_mov_b32 v68, 0
    v_mov_b32 v69, 0
    v_mov_b32 v70, 0
    v_mov_b32 v71, 0
    s_waitcnt vmcnt(2) lgkmcnt(0)
    s_barrier
    ds_read_b32 v22, v9 offset:0
    ds_read_b128 v[24:27], v8 offset:0
    ds_read_b128 v[28:31], v8 offset:1024
    s_waitcnt vmcnt(0)
    v_lshlrev_b32 v1, 16, v20
    v_and_b32 v3, 0xffff0000, v20
    v_mul_f32 v1, s33, v1
    v_mul_f32 v3, s33, v3
    v_cvt_pk_bf16_f32 v20, v1, v3
    s_mov_b32 s44, 0
    s_mov_b32 s45, -1
    v_mov_b32 v165, 0
    v_mov_b32 v167, 0
    v_cndmask_b32 v164, v20, v165, s[44:45]
    v_cndmask_b32 v166, v167, v20, s[44:45]
    v_lshlrev_b32 v1, 16, v16
    v_and_b32 v3, 0xffff0000, v16
    v_mul_f32 v1, s33, v1
    v_mul_f32 v3, s33, v3
    v_cvt_pk_bf16_f32 v16, v1, v3
    v_lshlrev_b32 v1, 16, v17
    v_and_b32 v3, 0xffff0000, v17
    v_mul_f32 v1, s33, v1
    v_mul_f32 v3, s33, v3
    v_cvt_pk_bf16_f32 v17, v1, v3
    v_lshlrev_b32 v1, 16, v18
    v_and_b32 v3, 0xffff0000, v18
    v_mul_f32 v1, s33, v1
    v_mul_f32 v3, s33, v3
    v_cvt_pk_bf16_f32 v18, v1, v3
    v_lshlrev_b32 v1, 16, v19
    v_and_b32 v3, 0xffff0000, v19
    v_mul_f32 v1, s33, v1
    v_mul_f32 v3, s33, v3
    v_cvt_pk_bf16_f32 v19, v1, v3
    s_cmp_ge_u32 s24, 4
    s_cselect_b64 vcc, -1, 0
    s_waitcnt lgkmcnt(2)
    v_mfma_f32_32x32x8_bf16 v[88:103], v[22:23], v[164:165], 0
    s_waitcnt lgkmcnt(1)
    v_mfma_f32_32x32x16_bf16 v[88:103], v[24:27], v[16:19], v[88:103]
    ds_read_b128 v[24:27], v8 offset:2048
    v_mfma_f32_32x32x8_bf16 v[104:119], v[22:23], v[166:167], 0
    ds_read_b32 v22, v9 offset:256
    s_waitcnt lgkmcnt(2)
    v_mfma_f32_32x32x16_bf16 v[104:119], v[28:31], v[16:19], v[104:119]
    ds_read_b128 v[28:31], v8 offset:3072
    s_cbranch_vccz L_pr0
    s_setprio 1
L_pr0:
    v_exp_f32 v88, v88
    v_exp_f32 v89, v89
    v_exp_f32 v90, v90
    v_exp_f32 v91, v91
    s_waitcnt lgkmcnt(1)
    v_mfma_f32_32x32x4_2b_bf16 v[120:151], v[22:23], v[20:21], 0
    ds_read_b32 v22, v9 offset:512
    v_exp_f32 v92, v92
    v_exp_f32 v93, v93
    v_exp_f32 v94, v94
    v_exp_f32 v95, v95
    ds_read_b32 v162, v163
    v_exp_f32 v96, v96
    v_exp_f32 v97, v97
    v_exp_f32 v98, v98
    v_exp_f32 v99, v99
    v_exp_f32 v100, v100
    v_exp_f32 v101, v101
    v_exp_f32 v102, v102
    v_mfma_f32_32x32x16_bf16 v[120:135], v[24:27], v[16:19], v[120:135]
    ds_read_b128 v[24:27], v8 offset:4096
    v_exp_f32 v103, v103
    s_waitcnt lgkmcnt(1)
    v_readfirstlane_b32 s47, v162
    s_nop 1
    s_sub_u32 s47, s47, 0x10001
    s_andn2_b32 s47, 0x80008000, s47
    s_cbranch_scc0 L_ok1
L_spin1:
    ds_read_b32 v162, v163
    s_waitcnt lgkmcnt(0)
    v_readfirstlane_b32 s47, v162
    s_nop 1
    s_sub_u32 s47, s47, 0x10001
    s_andn2_b32 s47, 0x80008000, s47
    s_cbranch_scc1 L_spin1
L_ok1:
    ds_read_b128 v[32:35], v10 offset:0
    ds_read_b128 v[36:39], v10 offset:32
    ds_read_b128 v[40:43], v10 offset:64
    ds_read_b128 v[44:47], v10 offset:96
    v_exp_f32 v104, v104
    v_exp_f32 v105, v105
    v_exp_f32 v106, v106
    s_waitcnt lgkmcnt(3)
    v_smfmac_f32_32x32x32_bf16 v[56:71], v[32:35], v[88:95], v48
    ds_read_b128 v[32:35], v10 offset:128
    v_exp_f32 v107, v107
    v_exp_f32 v108, v108
    s_waitcnt lgkmcnt(3)
    v_smfmac_f32_32x32x32_bf16 v[56:71], v[36:39], v[96:103], v48
    ds_read_b128 v[36:39], v10 offset:160
    v_exp_f32 v109, v109
    v_exp_f32 v110, v110
    v_mfma_f32_32x32x16_bf16 v[136:151], v[28:31], v[16:19], v[136:151]
    ds_read_b128 v[28:31], v8 offset:5120
    v_exp_f32 v111, v111
    v_exp_f32 v112, v112
    v_exp_f32 v113, v113
    s_waitcnt lgkmcnt(3)
    v_smfmac_f32_32x32x32_bf16 v[56:71], v[40:43], v[104:111], v48
    ds_read_b128 v[40:43], v10 offset:192
    v_exp_f32 v114, v114
    v_exp_f32 v115, v115
    v_exp_f32 v116, v116
    v_exp_f32 v117, v117
    v_exp_f32 v118, v118
    v_exp_f32 v119, v119
    v_exp_f32 v120, v120
    v_exp_f32 v121, v121
    v_smfmac_f32_32x32x32_bf16 v[56:71], v[44:47], v[112:119], v48
    ds_read_b128 v[44:47], v10 offset:224
    v_exp_f32 v122, v122
    v_exp_f32 v123, v123
    v_mfma_f32_32x32x4_2b_bf16 v[88:119], v[22:23], v[20:21], 0
    ds_read_b32 v22, v9 offset:768
    v_exp_f32 v124, v124
    v_exp_f32 v125, v125
    v_exp_f32 v126, v126
    v_exp_f32 v127, v127
    v_exp_f32 v128, v128
    v_exp_f32 v129, v129
    v_exp_f32 v130, v130
    v_exp_f32 v131, v131
    s_waitcnt lgkmcnt(3)
    v_smfmac_f32_32x32x32_bf16 v[56:71], v[32:35], v[120:127], v48
    ds_read_b128 v[32:35], v10 offset:256
    v_exp_f32 v132, v132
    v_exp_f32 v133, v133
    v_exp_f32 v134, v134
    v_mfma_f32_32x32x16_bf16 v[88:103], v[24:27], v[16:19], v[88:103]
    ds_read_b128 v[24:27], v8 offset:6144
    v_exp_f32 v135, v135
    v_exp_f32 v136, v136
    v_exp_f32 v137, v137
    v_exp_f32 v138, v138
    v_smfmac_f32_32x32x32_bf16 v[56:71], v[36:39], v[128:135], v48
    ds_read_b128 v[36:39], v10 offset:288
    v_exp_f32 v139, v139
    v_exp_f32 v140, v140
    v_exp_f32 v141, v141
    v_mfma_f32_32x32x16_bf16 v[104:119], v[28:31], v[16:19], v[104:119]
    ds_read_b128 v[28:31], v8 offset:7168
    v_exp_f32 v142, v142
    v_exp_f32 v143, v143
    ds_read_b32 v162, v163
    v_exp_f32 v144, v144
    v_exp_f32 v145, v145
    s_waitcnt lgkmcnt(3)
    v_smfmac_f32_32x32x32_bf16 v[56:71], v[40:43], v[136:143], v48
    ds_read_b128 v[40:43], v10 offset:320
    v_exp_f32 v146, v146
    v_exp_f32 v147, v147
    v_exp_f32 v148, v148
    v_exp_f32 v149, v149
    v_exp_f32 v150, v150
    v_exp_f32 v151, v151
    s_waitcnt lgkmcnt(1)
    v_readfirstlane_b32 s47, v162
    s_nop 1
    s_sub_u32 s47, s47, 0x20002
    s_andn2_b32 s47, 0x80008000, s47
    s_cbranch_scc0 L_ok2
L_spin2:
    ds_read_b32 v162, v163
    s_waitcnt lgkmcnt(0)
    v_readfirstlane_b32 s47, v162
    s_nop 1
    s_sub_u32 s47, s47, 0x20002
    s_andn2_b32 s47, 0x80008000, s47
    s_cbranch_scc1 L_spin2
L_ok2:
    v_exp_f32 v88, v88
    v_exp_f32 v89, v89
    v_smfmac_f32_32x32x32_bf16 v[56:71], v[44:47], v[144:151], v48
    ds_read_b128 v[44:47], v10 offset:352
    v_exp_f32 v90, v90
    v_exp_f32 v91, v91
    v_mfma_f32_32x32x4_2b_bf16 v[120:151], v[22:23], v[20:21], 0
    ds_read_b32 v22, v9 offset:1024
    v_exp_f32 v92, v92
    v_exp_f32 v93, v93
    v_exp_f32 v94, v94
    v_exp_f32 v95, v95
    v_exp_f32 v96, v96
    v_exp_f32 v97, v97
    v_exp_f32 v98, v98
    v_exp_f32 v99, v99
    v_smfmac_f32_32x32x32_bf16 v[56:71], v[32:35], v[88:95], v48
    ds_read_b128 v[32:35], v10 offset:384
    v_exp_f32 v100, v100
    v_exp_f32 v101, v101
    v_exp_f32 v102, v102
    v_mfma_f32_32x32x16_bf16 v[120:135], v[24:27], v[16:19], v[120:135]
    ds_read_b128 v[24:27], v8 offset:8192
    v_exp_f32 v103, v103
    v_exp_f32 v104, v104
    v_exp_f32 v105, v105
    v_exp_f32 v106, v106
    v_smfmac_f32_32x32x32_bf16 v[56:71], v[36:39], v[96:103], v48
    ds_read_b128 v[36:39], v10 offset:416
    v_exp_f32 v107, v107
    v_exp_f32 v108, v108
    v_exp_f32 v109, v109
    v_mfma_f32_32x32x16_bf16 v[136:151], v[28:31], v[16:19], v[136:151]
    ds_read_b128 v[28:31], v8 offset:9216
    v_exp_f32 v110, v110
    v_exp_f32 v111, v111
    v_exp_f32 v112, v112
    v_exp_f32 v113, v113
    s_waitcnt lgkmcnt(3)
    v_smfmac_f32_32x32x32_bf16 v[56:71], v[40:43], v[104:111], v48
    ds_read_b128 v[40:43], v10 offset:448
    v_exp_f32 v114, v114
    v_exp_f32 v115, v115
    v_exp_f32 v116, v116
    v_exp_f32 v117, v117
    v_exp_f32 v118, v118
    v_exp_f32 v119, v119
    v_exp_f32 v120, v120
    v_exp_f32 v121, v121
    v_smfmac_f32_32x32x32_bf16 v[56:71], v[44:47], v[112:119], v48
    ds_read_b128 v[44:47], v10 offset:480
    v_exp_f32 v122, v122
    v_exp_f32 v123, v123
    v_mfma_f32_32x32x4_2b_bf16 v[88:119], v[22:23], v[20:21], 0
    ds_read_b32 v22, v9 offset:1280
    v_exp_f32 v124, v124
    v_exp_f32 v125, v125
    v_exp_f32 v126, v126
    v_exp_f32 v127, v127
    v_exp_f32 v128, v128
    v_exp_f32 v129, v129
    v_exp_f32 v130, v130
    v_exp_f32 v131, v131
    v_smfmac_f32_32x32x32_bf16 v[56:71], v[32:35], v[120:127], v48
    ds_read_b128 v[32:35], v10 offset:512
    v_exp_f32 v132, v132
    v_exp_f32 v133, v133
    v_exp_f32 v134, v134
    s_waitcnt lgkmcnt(3)
    v_mfma_f32_32x32x16_bf16 v[88:103], v[24:27], v[16:19], v[88:103]
    ds_read_b128 v[24:27], v8 offset:10240
    v_exp_f32 v135, v135
    v_exp_f32 v136, v136
    v_exp_f32 v137, v137
    v_exp_f32 v138, v138
    v_smfmac_f32_32x32x32_bf16 v[56:71], v[36:39], v[128:135], v48
    ds_read_b128 v[36:39], v10 offset:544
    v_exp_f32 v139, v139
    v_exp_f32 v140, v140
    v_exp_f32 v141, v141
    v_mfma_f32_32x32x16_bf16 v[104:119], v[28:31], v[16:19], v[104:119]
    ds_read_b128 v[28:31], v8 offset:11264
    v_exp_f32 v142, v142
    v_exp_f32 v143, v143
    v_exp_f32 v144, v144
    v_exp_f32 v145, v145
    v_smfmac_f32_32x32x32_bf16 v[56:71], v[40:43], v[136:143], v48
    ds_read_b128 v[40:43], v10 offset:576
    v_exp_f32 v146, v146
    v_exp_f32 v147, v147
    v_exp_f32 v148, v148
    v_exp_f32 v149, v149
    v_exp_f32 v150, v150
    v_exp_f32 v151, v151
    v_exp_f32 v88, v88
    v_exp_f32 v89, v89
    s_waitcnt lgkmcnt(3)
    v_smfmac_f32_32x32x32_bf16 v[56:71], v[44:47], v[144:151], v48
    ds_read_b128 v[44:47], v10 offset:608
    v_exp_f32 v90, v90
    v_exp_f32 v91, v91
    v_mfma_f32_32x32x4_2b_bf16 v[120:151], v[22:23], v[20:21], 0
    ds_read_b32 v22, v9 offset:1536
    v_exp_f32 v92, v92
    v_exp_f32 v93, v93
    v_exp_f32 v94, v94
    v_exp_f32 v95, v95
    v_exp_f32 v96, v96
    v_exp_f32 v97, v97
    v_exp_f32 v98, v98
    v_exp_f32 v99, v99
    v_smfmac_f32_32x32x32_bf16 v[56:71], v[32:35], v[88:95], v48
    ds_read_b128 v[32:35], v10 offset:640
    v_exp_f32 v100, v100
    v_exp_f32 v101, v101
    v_exp_f32 v102, v102
    v_mfma_f32_32x32x16_bf16 v[120:135], v[24:27], v[16:19], v[120:135]
    ds_read_b128 v[24:27], v8 offset:12288
    v_exp_f32 v103, v103
    v_exp_f32 v104, v104
    v_exp_f32 v105, v105
    v_exp_f32 v106, v106
    s_waitcnt lgkmcnt(3)
    v_smfmac_f32_32x32x32_bf16 v[56:71], v[36:39], v[96:103], v48
    ds_read_b128 v[36:39], v10 offset:672
    v_exp_f32 v107, v107
    v_exp_f32 v108, v108
    v_exp_f32 v109, v109
    v_mfma_f32_32x32x16_bf16 v[136:151], v[28:31], v[16:19], v[136:151]
    ds_read_b128 v[28:31], v8 offset:13312
    v_exp_f32 v110, v110
    v_exp_f32 v111, v111
    v_exp_f32 v112, v112
    v_exp_f32 v113, v113
    v_smfmac_f32_32x32x32_bf16 v[56:71], v[40:43], v[104:111], v48
    ds_read_b128 v[40:43], v10 offset:704
    v_exp_f32 v114, v114
    v_exp_f32 v115, v115
    v_exp_f32 v116, v116
    v_exp_f32 v117, v117
    v_exp_f32 v118, v118
    v_exp_f32 v119, v119
    v_exp_f32 v120, v120
    v_exp_f32 v121, v121
    v_smfmac_f32_32x32x32_bf16 v[56:71], v[44:47], v[112:119], v48
    ds_read_b128 v[44:47], v10 offset:736
    v_exp_f32 v122, v122
    v_exp_f32 v123, v123
    s_waitcnt lgkmcnt(3)
    v_mfma_f32_32x32x4_2b_bf16 v[88:119], v[22:23], v[20:21], 0
    ds_read_b32 v22, v9 offset:1792
    v_exp_f32 v124, v124
    v_exp_f32 v125, v125
    v_exp_f32 v126, v126
    v_exp_f32 v127, v127
    v_exp_f32 v128, v128
    v_exp_f32 v129, v129
    v_exp_f32 v130, v130
    v_exp_f32 v131, v131
    v_smfmac_f32_32x32x32_bf16 v[56:71], v[32:35], v[120:127], v48
    ds_read_b128 v[32:35], v10 offset:768
    v_exp_f32 v132, v132
    v_exp_f32 v133, v133
    v_exp_f32 v134, v134
    v_mfma_f32_32x32x16_bf16 v[88:103], v[24:27], v[16:19], v[88:103]
    ds_read_b128 v[24:27], v8 offset:14336
    v_exp_f32 v135, v135
    v_exp_f32 v136, v136
    v_exp_f32 v137, v137
    v_exp_f32 v138, v138
    v_smfmac_f32_32x32x32_bf16 v[56:71], v[36:39], v[128:135], v48
    ds_read_b128 v[36:39], v10 offset:800
    v_exp_f32 v139, v139
    v_exp_f32 v140, v140
    v_exp_f32 v141, v141
    s_waitcnt lgkmcnt(3)
    v_mfma_f32_32x32x16_bf16 v[104:119], v[28:31], v[16:19], v[104:119]
    ds_read_b128 v[28:31], v8 offset:15360
    v_exp_f32 v142, v142
    v_exp_f32 v143, v143
    ds_read_b32 v162, v163
    v_exp_f32 v144, v144
    v_exp_f32 v145, v145
    v_smfmac_f32_32x32x32_bf16 v[56:71], v[40:43], v[136:143], v48
    ds_read_b128 v[40:43], v10 offset:832
    v_exp_f32 v146, v146
    v_exp_f32 v147, v147
    v_exp_f32 v148, v148
    v_exp_f32 v149, v149
    v_exp_f32 v150, v150
    v_exp_f32 v151, v151
    s_waitcnt lgkmcnt(1)
    v_readfirstlane_b32 s47, v162
    s_nop 1
    s_sub_u32 s47, s47, 0x30003
    s_andn2_b32 s47, 0x80008000, s47
    s_cbranch_scc0 L_ok3
L_spin3:
    ds_read_b32 v162, v163
    s_waitcnt lgkmcnt(0)
    v_readfirstlane_b32 s47, v162
    s_nop 1
    s_sub_u32 s47, s47, 0x30003
    s_andn2_b32 s47, 0x80008000, s47
    s_cbranch_scc1 L_spin3
L_ok3:
    v_exp_f32 v88, v88
    v_exp_f32 v89, v89
    v_smfmac_f32_32x32x32_bf16 v[56:71], v[44:47], v[144:151], v48
    ds_read_b128 v[44:47], v10 offset:864
    v_exp_f32 v90, v90
    v_exp_f32 v91, v91
    v_mfma_f32_32x32x4_2b_bf16 v[120:151], v[22:23], v[20:21], 0
    ds_read_b32 v22, v9 offset:2048
    v_exp_f32 v92, v92
    v_exp_f32 v93, v93
    v_exp_f32 v94, v94
    v_exp_f32 v95, v95
    v_exp_f32 v96, v96
    v_exp_f32 v97, v97
    v_exp_f32 v98, v98
    v_exp_f32 v99, v99
    v_smfmac_f32_32x32x32_bf16 v[56:71], v[32:35], v[88:95], v48
    ds_read_b128 v[32:35], v10 offset:896
    v_exp_f32 v100, v100
    v_exp_f32 v101, v101
    v_exp_f32 v102, v102
    v_mfma_f32_32x32x16_bf16 v[120:135], v[24:27], v[16:19], v[120:135]
    ds_read_b128 v[24:27], v8 offset:16384
    v_exp_f32 v103, v103
    v_exp_f32 v104, v104
    v_exp_f32 v105, v105
    v_exp_f32 v106, v106
    v_smfmac_f32_32x32x32_bf16 v[56:71], v[36:39], v[96:103], v48
    ds_read_b128 v[36:39], v10 offset:928
    v_exp_f32 v107, v107
    v_exp_f32 v108, v108
    v_exp_f32 v109, v109
    v_mfma_f32_32x32x16_bf16 v[136:151], v[28:31], v[16:19], v[136:151]
    ds_read_b128 v[28:31], v8 offset:17408
    v_exp_f32 v110, v110
    v_exp_f32 v111, v111
    v_exp_f32 v112, v112
    v_exp_f32 v113, v113
    s_waitcnt lgkmcnt(3)
    v_smfmac_f32_32x32x32_bf16 v[56:71], v[40:43], v[104:111], v48
    ds_read_b128 v[40:43], v10 offset:960
    v_exp_f32 v114, v114
    v_exp_f32 v115, v115
    v_exp_f32 v116, v116
    v_exp_f32 v117, v117
    v_exp_f32 v118, v118
    v_exp_f32 v119, v119
    v_exp_f32 v120, v120
    v_exp_f32 v121, v121
    v_smfmac_f32_32x32x32_bf16 v[56:71], v[44:47], v[112:119], v48
    ds_read_b128 v[44:47], v10 offset:992
    v_exp_f32 v122, v122
    v_exp_f32 v123, v123
    v_mfma_f32_32x32x4_2b_bf16 v[88:119], v[22:23], v[20:21], 0
    ds_read_b32 v22, v9 offset:2304
    v_exp_f32 v124, v124
    v_exp_f32 v125, v125
    v_exp_f32 v126, v126
    v_exp_f32 v127, v127
    v_exp_f32 v128, v128
    v_exp_f32 v129, v129
    v_exp_f32 v130, v130
    v_exp_f32 v131, v131
    v_smfmac_f32_32x32x32_bf16 v[56:71], v[32:35], v[120:127], v48
    ds_read_b128 v[32:35], v10 offset:1024
    v_exp_f32 v132, v132
    v_exp_f32 v133, v133
    v_exp_f32 v134, v134
    s_waitcnt lgkmcnt(3)
    v_mfma_f32_32x32x16_bf16 v[88:103], v[24:27], v[16:19], v[88:103]
    ds_read_b128 v[24:27], v8 offset:18432
    v_exp_f32 v135, v135
    v_exp_f32 v136, v136
    v_exp_f32 v137, v137
    v_exp_f32 v138, v138
    v_smfmac_f32_32x32x32_bf16 v[56:71], v[36:39], v[128:135], v48
    ds_read_b128 v[36:39], v10 offset:1056
    v_exp_f32 v139, v139
    v_exp_f32 v140, v140
    v_exp_f32 v141, v141
    v_mfma_f32_32x32x16_bf16 v[104:119], v[28:31], v[16:19], v[104:119]
    ds_read_b128 v[28:31], v8 offset:19456
    v_exp_f32 v142, v142
    v_exp_f32 v143, v143
    v_exp_f32 v144, v144
    v_exp_f32 v145, v145
    v_smfmac_f32_32x32x32_bf16 v[56:71], v[40:43], v[136:143], v48
    ds_read_b128 v[40:43], v10 offset:1088
    v_exp_f32 v146, v146
    v_exp_f32 v147, v147
    v_exp_f32 v148, v148
    v_exp_f32 v149, v149
    v_exp_f32 v150, v150
    v_exp_f32 v151, v151
    v_exp_f32 v88, v88
    v_exp_f32 v89, v89
    s_waitcnt lgkmcnt(3)
    v_smfmac_f32_32x32x32_bf16 v[56:71], v[44:47], v[144:151], v48
    ds_read_b128 v[44:47], v10 offset:1120
    v_exp_f32 v90, v90
    v_exp_f32 v91, v91
    v_mfma_f32_32x32x4_2b_bf16 v[120:151], v[22:23], v[20:21], 0
    ds_read_b32 v22, v9 offset:2560
    v_exp_f32 v92, v92
    v_exp_f32 v93, v93
    v_exp_f32 v94, v94
    v_exp_f32 v95, v95
    v_exp_f32 v96, v96
    v_exp_f32 v97, v97
    v_exp_f32 v98, v98
    v_exp_f32 v99, v99
    v_smfmac_f32_32x32x32_bf16 v[56:71], v[32:35], v[88:95], v48
    ds_read_b128 v[32:35], v10 offset:1152
    v_exp_f32 v100, v100
    v_exp_f32 v101, v101
    v_exp_f32 v102, v102
    v_mfma_f32_32x32x16_bf16 v[120:135], v[24:27], v[16:19], v[120:135]
    ds_read_b128 v[24:27], v8 offset:20480
    v_exp_f32 v103, v103
    v_exp_f32 v104, v104
    v_exp_f32 v105, v105
    v_exp_f32 v106, v106
    s_waitcnt lgkmcnt(3)
    v_smfmac_f32_32x32x32_bf16 v[56:71], v[36:39], v[96:103], v48
    ds_read_b128 v[36:39], v10 offset:1184
    v_exp_f32 v107, v107
    v_exp_f32 v108, v108
    v_exp_f32 v109, v109
    v_mfma_f32_32x32x16_bf16 v[136:151], v[28:31], v[16:19], v[136:151]
    ds_read_b128 v[28:31], v8 offset:21504
    v_exp_f32 v110, v110
    v_exp_f32 v111, v111
    v_exp_f32 v112, v112
    v_exp_f32 v113, v113
    v_smfmac_f32_32x32x32_bf16 v[56:71], v[40:43], v[104:111], v48
    ds_read_b128 v[40:43], v10 offset:1216
    v_exp_f32 v114, v114
    v_exp_f32 v115, v115
    v_exp_f32 v116, v116
    v_exp_f32 v117, v117
    v_exp_f32 v118, v118
    v_exp_f32 v119, v119
    v_exp_f32 v120, v120
    v_exp_f32 v121, v121
    v_smfmac_f32_32x32x32_bf16 v[56:71], v[44:47], v[112:119], v48
    ds_read_b128 v[44:47], v10 offset:1248
    v_exp_f32 v122, v122
    v_exp_f32 v123, v123
    s_waitcnt lgkmcnt(3)
    v_mfma_f32_32x32x4_2b_bf16 v[88:119], v[22:23], v[20:21], 0
    ds_read_b32 v22, v9 offset:2816
    v_exp_f32 v124, v124
    v_exp_f32 v125, v125
    v_exp_f32 v126, v126
    v_exp_f32 v127, v127
    v_exp_f32 v128, v128
    v_exp_f32 v129, v129
    v_exp_f32 v130, v130
    v_exp_f32 v131, v131
    v_smfmac_f32_32x32x32_bf16 v[56:71], v[32:35], v[120:127], v48
    ds_read_b128 v[32:35], v10 offset:1280
    v_exp_f32 v132, v132
    v_exp_f32 v133, v133
    v_exp_f32 v134, v134
    v_mfma_f32_32x32x16_bf16 v[88:103], v[24:27], v[16:19], v[88:103]
    ds_read_b128 v[24:27], v8 offset:22528
    v_exp_f32 v135, v135
    v_exp_f32 v136, v136
    v_exp_f32 v137, v137
    v_exp_f32 v138, v138
    v_smfmac_f32_32x32x32_bf16 v[56:71], v[36:39], v[128:135], v48
    ds_read_b128 v[36:39], v10 offset:1312
    v_exp_f32 v139, v139
    v_exp_f32 v140, v140
    v_exp_f32 v141, v141
    s_waitcnt lgkmcnt(3)
    v_mfma_f32_32x32x16_bf16 v[104:119], v[28:31], v[16:19], v[104:119]
    ds_read_b128 v[28:31], v8 offset:23552
    v_exp_f32 v142, v142
    v_exp_f32 v143, v143
    v_exp_f32 v144, v144
    v_exp_f32 v145, v145
    v_smfmac_f32_32x32x32_bf16 v[56:71], v[40:43], v[136:143], v48
    ds_read_b128 v[40:43], v10 offset:1344
    v_exp_f32 v146, v146
    v_exp_f32 v147, v147
    v_exp_f32 v148, v148
    v_exp_f32 v149, v149
    v_exp_f32 v150, v150
    v_exp_f32 v151, v151
    v_exp_f32 v88, v88
    v_exp_f32 v89, v89
    v_smfmac_f32_32x32x32_bf16 v[56:71], v[44:47], v[144:151], v48
    ds_read_b128 v[44:47], v10 offset:1376
    v_exp_f32 v90, v90
    v_exp_f32 v91, v91
    v_mfma_f32_32x32x4_2b_bf16 v[120:151], v[22:23], v[20:21], 0
    ds_read_b32 v22, v9 offset:3072
    v_exp_f32 v92, v92
    v_exp_f32 v93, v93
    v_exp_f32 v94, v94
    v_exp_f32 v95, v95
    v_exp_f32 v96, v96
    v_exp_f32 v97, v97
    v_exp_f32 v98, v98
    v_exp_f32 v99, v99
    s_waitcnt lgkmcnt(3)
    v_smfmac_f32_32x32x32_bf16 v[56:71], v[32:35], v[88:95], v48
    ds_read_b128 v[32:35], v10 offset:1408
    v_exp_f32 v100, v100
    v_exp_f32 v101, v101
    v_exp_f32 v102, v102
    v_mfma_f32_32x32x16_bf16 v[120:135], v[24:27], v[16:19], v[120:135]
    ds_read_b128 v[24:27], v8 offset:24576
    v_exp_f32 v103, v103
    v_exp_f32 v104, v104
    v_exp_f32 v105, v105
    v_exp_f32 v106, v106
    v_smfmac_f32_32x32x32_bf16 v[56:71], v[36:39], v[96:103], v48
    ds_read_b128 v[36:39], v10 offset:1440
    v_exp_f32 v107, v107
    v_exp_f32 v108, v108
    v_exp_f32 v109, v109
    v_mfma_f32_32x32x16_bf16 v[136:151], v[28:31], v[16:19], v[136:151]
    ds_read_b128 v[28:31], v8 offset:25600
    v_exp_f32 v110, v110
    v_exp_f32 v111, v111
    v_exp_f32 v112, v112
    v_exp_f32 v113, v113
    s_waitcnt lgkmcnt(3)
    v_smfmac_f32_32x32x32_bf16 v[56:71], v[40:43], v[104:111], v48
    ds_read_b128 v[40:43], v10 offset:1472
    v_exp_f32 v114, v114
    v_exp_f32 v115, v115
    v_exp_f32 v116, v116
    v_exp_f32 v117, v117
    v_exp_f32 v118, v118
    v_exp_f32 v119, v119
    v_exp_f32 v120, v120
    v_exp_f32 v121, v121
    v_smfmac_f32_32x32x32_bf16 v[56:71], v[44:47], v[112:119], v48
    ds_read_b128 v[44:47], v10 offset:1504
    v_exp_f32 v122, v122
    v_exp_f32 v123, v123
    v_mfma_f32_32x32x4_2b_bf16 v[88:119], v[22:23], v[20:21], 0
    ds_read_b32 v22, v9 offset:3328
    v_exp_f32 v124, v124
    v_exp_f32 v125, v125
    v_exp_f32 v126, v126
    v_exp_f32 v127, v127
    v_exp_f32 v128, v128
    v_exp_f32 v129, v129
    v_exp_f32 v130, v130
    v_exp_f32 v131, v131
    v_smfmac_f32_32x32x32_bf16 v[56:71], v[32:35], v[120:127], v48
    ds_read_b128 v[32:35], v10 offset:1536
    v_exp_f32 v132, v132
    v_exp_f32 v133, v133
    v_exp_f32 v134, v134
    s_waitcnt lgkmcnt(3)
    v_mfma_f32_32x32x16_bf16 v[88:103], v[24:27], v[16:19], v[88:103]
    ds_read_b128 v[24:27], v8 offset:26624
    v_exp_f32 v135, v135
    v_exp_f32 v136, v136
    v_exp_f32 v137, v137
    v_exp_f32 v138, v138
    v_smfmac_f32_32x32x32_bf16 v[56:71], v[36:39], v[128:135], v48
    ds_read_b128 v[36:39], v10 offset:1568
    v_exp_f32 v139, v139
    v_exp_f32 v140, v140
    v_exp_f32 v141, v141
    v_mfma_f32_32x32x16_bf16 v[104:119], v[28:31], v[16:19], v[104:119]
    ds_read_b128 v[28:31], v8 offset:27648
    v_exp_f32 v142, v142
    v_exp_f32 v143, v143
    v_exp_f32 v144, v144
    v_exp_f32 v145, v145
    v_smfmac_f32_32x32x32_bf16 v[56:71], v[40:43], v[136:143], v48
    ds_read_b128 v[40:43], v10 offset:1600
    v_exp_f32 v146, v146
    v_exp_f32 v147, v147
    v_exp_f32 v148, v148
    v_exp_f32 v149, v149
    v_exp_f32 v150, v150
    v_exp_f32 v151, v151
    v_exp_f32 v88, v88
    v_exp_f32 v89, v89
    s_waitcnt lgkmcnt(3)
    v_smfmac_f32_32x32x32_bf16 v[56:71], v[44:47], v[144:151], v48
    ds_read_b128 v[44:47], v10 offset:1632
    v_exp_f32 v90, v90
    v_exp_f32 v91, v91
    v_mfma_f32_32x32x4_2b_bf16 v[120:151], v[22:23], v[20:21], 0
    ds_read_b32 v22, v9 offset:3584
    v_exp_f32 v92, v92
    v_exp_f32 v93, v93
    v_exp_f32 v94, v94
    v_exp_f32 v95, v95
    v_exp_f32 v96, v96
    v_exp_f32 v97, v97
    v_exp_f32 v98, v98
    v_exp_f32 v99, v99
    v_smfmac_f32_32x32x32_bf16 v[56:71], v[32:35], v[88:95], v48
    ds_read_b128 v[32:35], v10 offset:1664
    v_exp_f32 v100, v100
    v_exp_f32 v101, v101
    v_exp_f32 v102, v102
    v_mfma_f32_32x32x16_bf16 v[120:135], v[24:27], v[16:19], v[120:135]
    ds_read_b128 v[24:27], v8 offset:28672
    v_exp_f32 v103, v103
    v_exp_f32 v104, v104
    v_exp_f32 v105, v105
    v_exp_f32 v106, v106
    s_waitcnt lgkmcnt(3)
    v_smfmac_f32_32x32x32_bf16 v[56:71], v[36:39], v[96:103], v48
    ds_read_b128 v[36:39], v10 offset:1696
    v_exp_f32 v107, v107
    v_exp_f32 v108, v108
    v_exp_f32 v109, v109
    v_mfma_f32_32x32x16_bf16 v[136:151], v[28:31], v[16:19], v[136:151]
    ds_read_b128 v[28:31], v8 offset:29696
    v_exp_f32 v110, v110
    v_exp_f32 v111, v111
    v_exp_f32 v112, v112
    v_exp_f32 v113, v113
    v_smfmac_f32_32x32x32_bf16 v[56:71], v[40:43], v[104:111], v48
    ds_read_b128 v[40:43], v10 offset:1728
    v_exp_f32 v114, v114
    v_exp_f32 v115, v115
    v_exp_f32 v116, v116
    v_exp_f32 v117, v117
    v_exp_f32 v118, v118
    v_exp_f32 v119, v119
    v_exp_f32 v120, v120
    v_exp_f32 v121, v121
    v_smfmac_f32_32x32x32_bf16 v[56:71], v[44:47], v[112:119], v48
    ds_read_b128 v[44:47], v10 offset:1760
    v_exp_f32 v122, v122
    v_exp_f32 v123, v123
    s_waitcnt lgkmcnt(3)
    v_mfma_f32_32x32x4_2b_bf16 v[88:119], v[22:23], v[20:21], 0
    ds_read_b32 v22, v9 offset:3840
    v_exp_f32 v124, v124
    v_exp_f32 v125, v125
    v_exp_f32 v126, v126
    v_exp_f32 v127, v127
    v_exp_f32 v128, v128
    v_exp_f32 v129, v129
    v_exp_f32 v130, v130
    v_exp_f32 v131, v131
    v_smfmac_f32_32x32x32_bf16 v[56:71], v[32:35], v[120:127], v48
    ds_read_b128 v[32:35], v10 offset:1792
    v_exp_f32 v132, v132
    v_exp_f32 v133, v133
    v_exp_f32 v134, v134
    v_mfma_f32_32x32x16_bf16 v[88:103], v[24:27], v[16:19], v[88:103]
    ds_read_b128 v[24:27], v8 offset:30720
    v_exp_f32 v135, v135
    v_exp_f32 v136, v136
    v_exp_f32 v137, v137
    v_exp_f32 v138, v138
    v_smfmac_f32_32x32x32_bf16 v[56:71], v[36:39], v[128:135], v48
    ds_read_b128 v[36:39], v10 offset:1824
    v_exp_f32 v139, v139
    v_exp_f32 v140, v140
    v_exp_f32 v141, v141
    s_waitcnt lgkmcnt(3)
    v_mfma_f32_32x32x16_bf16 v[104:119], v[28:31], v[16:19], v[104:119]
    ds_read_b128 v[28:31], v8 offset:31744
    v_exp_f32 v142, v142
    v_exp_f32 v143, v143
    ds_read_b32 v162, v163
    v_exp_f32 v144, v144
    v_exp_f32 v145, v145
    v_smfmac_f32_32x32x32_bf16 v[56:71], v[40:43], v[136:143], v48
    ds_read_b128 v[40:43], v10 offset:1856
    v_exp_f32 v146, v146
    v_exp_f32 v147, v147
    v_exp_f32 v148, v148
    v_exp_f32 v149, v149
    v_exp_f32 v150, v150
    v_exp_f32 v151, v151
    s_waitcnt lgkmcnt(1)
    v_readfirstlane_b32 s47, v162
    s_nop 1
    s_sub_u32 s47, s47, 0x40004
    s_andn2_b32 s47, 0x80008000, s47
    s_cbranch_scc0 L_ok4
L_spin4:
    ds_read_b32 v162, v163
    s_waitcnt lgkmcnt(0)
    v_readfirstlane_b32 s47, v162
    s_nop 1
    s_sub_u32 s47, s47, 0x40004
    s_andn2_b32 s47, 0x80008000, s47
    s_cbranch_scc1 L_spin4
L_ok4:
    v_exp_f32 v88, v88
    v_exp_f32 v89, v89
    v_smfmac_f32_32x32x32_bf16 v[56:71], v[44:47], v[144:151], v48
    ds_read_b128 v[44:47], v10 offset:1888
    v_exp_f32 v90, v90
    v_exp_f32 v91, v91
    v_mfma_f32_32x32x4_2b_bf16 v[120:151], v[22:23], v[20:21], 0
    ds_read_b32 v22, v9 offset:4096
    v_exp_f32 v92, v92
    v_exp_f32 v93, v93
    v_exp_f32 v94, v94
    v_exp_f32 v95, v95
    v_exp_f32 v96, v96
    v_exp_f32 v97, v97
    v_exp_f32 v98, v98
    v_exp_f32 v99, v99
    v_smfmac_f32_32x32x32_bf16 v[56:71], v[32:35], v[88:95], v48
    ds_read_b128 v[32:35], v10 offset:1920
    v_exp_f32 v100, v100
    v_exp_f32 v101, v101
    v_exp_f32 v102, v102
    v_mfma_f32_32x32x16_bf16 v[120:135], v[24:27], v[16:19], v[120:135]
    ds_read_b128 v[24:27], v8 offset:32768
    v_exp_f32 v103, v103
    v_exp_f32 v104, v104
    v_exp_f32 v105, v105
    v_exp_f32 v106, v106
    v_smfmac_f32_32x32x32_bf16 v[56:71], v[36:39], v[96:103], v48
    ds_read_b128 v[36:39], v10 offset:1952
    v_exp_f32 v107, v107
    v_exp_f32 v108, v108
    v_exp_f32 v109, v109
    v_mfma_f32_32x32x16_bf16 v[136:151], v[28:31], v[16:19], v[136:151]
    ds_read_b128 v[28:31], v8 offset:33792
    v_exp_f32 v110, v110
    v_exp_f32 v111, v111
    v_exp_f32 v112, v112
    v_exp_f32 v113, v113
    s_waitcnt lgkmcnt(3)
    v_smfmac_f32_32x32x32_bf16 v[56:71], v[40:43], v[104:111], v48
    ds_read_b128 v[40:43], v10 offset:1984
    v_exp_f32 v114, v114
    v_exp_f32 v115, v115
    v_exp_f32 v116, v116
    v_exp_f32 v117, v117
    v_exp_f32 v118, v118
    v_exp_f32 v119, v119
    v_exp_f32 v120, v120
    v_exp_f32 v121, v121
    v_smfmac_f32_32x32x32_bf16 v[56:71], v[44:47], v[112:119], v48
    ds_read_b128 v[44:47], v10 offset:2016
    v_exp_f32 v122, v122
    v_exp_f32 v123, v123
    v_mfma_f32_32x32x4_2b_bf16 v[88:119], v[22:23], v[20:21], 0
    ds_read_b32 v22, v9 offset:4352
    v_exp_f32 v124, v124
    v_exp_f32 v125, v125
    v_exp_f32 v126, v126
    v_exp_f32 v127, v127
    v_exp_f32 v128, v128
    v_exp_f32 v129, v129
    v_exp_f32 v130, v130
    v_exp_f32 v131, v131
    v_smfmac_f32_32x32x32_bf16 v[56:71], v[32:35], v[120:127], v48
    ds_read_b128 v[32:35], v10 offset:2048
    v_exp_f32 v132, v132
    v_exp_f32 v133, v133
    v_exp_f32 v134, v134
    s_waitcnt lgkmcnt(3)
    v_mfma_f32_32x32x16_bf16 v[88:103], v[24:27], v[16:19], v[88:103]
    ds_read_b128 v[24:27], v8 offset:34816
    v_exp_f32 v135, v135
    v_exp_f32 v136, v136
    v_exp_f32 v137, v137
    v_exp_f32 v138, v138
    v_smfmac_f32_32x32x32_bf16 v[56:71], v[36:39], v[128:135], v48
    ds_read_b128 v[36:39], v10 offset:2080
    v_exp_f32 v139, v139
    v_exp_f32 v140, v140
    v_exp_f32 v141, v141
    v_mfma_f32_32x32x16_bf16 v[104:119], v[28:31], v[16:19], v[104:119]
    ds_read_b128 v[28:31], v8 offset:35840
    v_exp_f32 v142, v142
    v_exp_f32 v143, v143
    v_exp_f32 v144, v144
    v_exp_f32 v145, v145
    v_smfmac_f32_32x32x32_bf16 v[56:71], v[40:43], v[136:143], v48
    ds_read_b128 v[40:43], v10 offset:2112
    v_exp_f32 v146, v146
    v_exp_f32 v147, v147
    v_exp_f32 v148, v148
    v_exp_f32 v149, v149
    v_exp_f32 v150, v150
    v_exp_f32 v151, v151
    v_exp_f32 v88, v88
    v_exp_f32 v89, v89
    s_waitcnt lgkmcnt(3)
    v_smfmac_f32_32x32x32_bf16 v[56:71], v[44:47], v[144:151], v48
    ds_read_b128 v[44:47], v10 offset:2144
    v_exp_f32 v90, v90
    v_exp_f32 v91, v91
    v_mfma_f32_32x32x4_2b_bf16 v[120:151], v[22:23], v[20:21], 0
    ds_read_b32 v22, v9 offset:4608
    v_exp_f32 v92, v92
    v_exp_f32 v93, v93
    v_exp_f32 v94, v94
    v_exp_f32 v95, v95
    v_exp_f32 v96, v96
    v_exp_f32 v97, v97
    v_exp_f32 v98, v98
    v_exp_f32 v99, v99
    v_smfmac_f32_32x32x32_bf16 v[56:71], v[32:35], v[88:95], v48
    ds_read_b128 v[32:35], v10 offset:2176
    v_exp_f32 v100, v100
    v_exp_f32 v101, v101
    v_exp_f32 v102, v102
    v_mfma_f32_32x32x16_bf16 v[120:135], v[24:27], v[16:19], v[120:135]
    ds_read_b128 v[24:27], v8 offset:36864
    v_exp_f32 v103, v103
    v_exp_f32 v104, v104
    v_exp_f32 v105, v105
    v_exp_f32 v106, v106
    s_waitcnt lgkmcnt(3)
    v_smfmac_f32_32x32x32_bf16 v[56:71], v[36:39], v[96:103], v48
    ds_read_b128 v[36:39], v10 offset:2208
    v_exp_f32 v107, v107
    v_exp_f32 v108, v108
    v_exp_f32 v109, v109
    v_mfma_f32_32x32x16_bf16 v[136:151], v[28:31], v[16:19], v[136:151]
    ds_read_b128 v[28:31], v8 offset:37888
    v_exp_f32 v110, v110
    v_exp_f32 v111, v111
    v_exp_f32 v112, v112
    v_exp_f32 v113, v113
    v_smfmac_f32_32x32x32_bf16 v[56:71], v[40:43], v[104:111], v48
    ds_read_b128 v[40:43], v10 offset:2240
    v_exp_f32 v114, v114
    v_exp_f32 v115, v115
    v_exp_f32 v116, v116
    v_exp_f32 v117, v117
    v_exp_f32 v118, v118
    v_exp_f32 v119, v119
    v_exp_f32 v120, v120
    v_exp_f32 v121, v121
    v_smfmac_f32_32x32x32_bf16 v[56:71], v[44:47], v[112:119], v48
    ds_read_b128 v[44:47], v10 offset:2272
    v_exp_f32 v122, v122
    v_exp_f32 v123, v123
    s_waitcnt lgkmcnt(3)
    v_mfma_f32_32x32x4_2b_bf16 v[88:119], v[22:23], v[20:21], 0
    ds_read_b32 v22, v9 offset:4864
    v_exp_f32 v124, v124
    v_exp_f32 v125, v125
    v_exp_f32 v126, v126
    v_exp_f32 v127, v127
    v_exp_f32 v128, v128
    v_exp_f32 v129, v129
    v_exp_f32 v130, v130
    v_exp_f32 v131, v131
    v_smfmac_f32_32x32x32_bf16 v[56:71], v[32:35], v[120:127], v48
    ds_read_b128 v[32:35], v10 offset:2304
    v_exp_f32 v132, v132
    v_exp_f32 v133, v133
    v_exp_f32 v134, v134
    v_mfma_f32_32x32x16_bf16 v[88:103], v[24:27], v[16:19], v[88:103]
    ds_read_b128 v[24:27], v8 offset:38912
    v_exp_f32 v135, v135
    v_exp_f32 v136, v136
    v_exp_f32 v137, v137
    v_exp_f32 v138, v138
    v_smfmac_f32_32x32x32_bf16 v[56:71], v[36:39], v[128:135], v48
    ds_read_b128 v[36:39], v10 offset:2336
    v_exp_f32 v139, v139
    v_exp_f32 v140, v140
    v_exp_f32 v141, v141
    s_waitcnt lgkmcnt(3)
    v_mfma_f32_32x32x16_bf16 v[104:119], v[28:31], v[16:19], v[104:119]
    ds_read_b128 v[28:31], v8 offset:39936
    v_exp_f32 v142, v142
    v_exp_f32 v143, v143
    v_exp_f32 v144, v144
    v_exp_f32 v145, v145
    v_smfmac_f32_32x32x32_bf16 v[56:71], v[40:43], v[136:143], v48
    ds_read_b128 v[40:43], v10 offset:2368
    v_exp_f32 v146, v146
    v_exp_f32 v147, v147
    v_exp_f32 v148, v148
    v_exp_f32 v149, v149
    v_exp_f32 v150, v150
    v_exp_f32 v151, v151
    v_exp_f32 v88, v88
    v_exp_f32 v89, v89
    v_smfmac_f32_32x32x32_bf16 v[56:71], v[44:47], v[144:151], v48
    ds_read_b128 v[44:47], v10 offset:2400
    v_exp_f32 v90, v90
    v_exp_f32 v91, v91
    v_mfma_f32_32x32x4_2b_bf16 v[120:151], v[22:23], v[20:21], 0
    ds_read_b32 v22, v9 offset:5120
    v_exp_f32 v92, v92
    v_exp_f32 v93, v93
    v_exp_f32 v94, v94
    v_exp_f32 v95, v95
    v_exp_f32 v96, v96
    v_exp_f32 v97, v97
    v_exp_f32 v98, v98
    v_exp_f32 v99, v99
    s_waitcnt lgkmcnt(3)
    v_smfmac_f32_32x32x32_bf16 v[56:71], v[32:35], v[88:95], v48
    ds_read_b128 v[32:35], v10 offset:2432
    v_exp_f32 v100, v100
    v_exp_f32 v101, v101
    v_exp_f32 v102, v102
    v_mfma_f32_32x32x16_bf16 v[120:135], v[24:27], v[16:19], v[120:135]
    ds_read_b128 v[24:27], v8 offset:40960
    v_exp_f32 v103, v103
    v_exp_f32 v104, v104
    v_exp_f32 v105, v105
    v_exp_f32 v106, v106
    v_smfmac_f32_32x32x32_bf16 v[56:71], v[36:39], v[96:103], v48
    ds_read_b128 v[36:39], v10 offset:2464
    v_exp_f32 v107, v107
    v_exp_f32 v108, v108
    v_exp_f32 v109, v109
    v_mfma_f32_32x32x16_bf16 v[136:151], v[28:31], v[16:19], v[136:151]
    ds_read_b128 v[28:31], v8 offset:41984
    v_exp_f32 v110, v110
    v_exp_f32 v111, v111
    v_exp_f32 v112, v112
    v_exp_f32 v113, v113
    s_waitcnt lgkmcnt(3)
    v_smfmac_f32_32x32x32_bf16 v[56:71], v[40:43], v[104:111], v48
    ds_read_b128 v[40:43], v10 offset:2496
    v_exp_f32 v114, v114
    v_exp_f32 v115, v115
    v_exp_f32 v116, v116
    v_exp_f32 v117, v117
    v_exp_f32 v118, v118
    v_exp_f32 v119, v119
    v_exp_f32 v120, v120
    v_exp_f32 v121, v121
    v_smfmac_f32_32x32x32_bf16 v[56:71], v[44:47], v[112:119], v48
    ds_read_b128 v[44:47], v10 offset:2528
    v_exp_f32 v122, v122
    v_exp_f32 v123, v123
    v_mfma_f32_32x32x4_2b_bf16 v[88:119], v[22:23], v[20:21], 0
    ds_read_b32 v22, v9 offset:5376
    v_exp_f32 v124, v124
    v_exp_f32 v125, v125
    v_exp_f32 v126, v126
    v_exp_f32 v127, v127
    v_exp_f32 v128, v128
    v_exp_f32 v129, v129
    v_exp_f32 v130, v130
    v_exp_f32 v131, v131
    v_smfmac_f32_32x32x32_bf16 v[56:71], v[32:35], v[120:127], v48
    ds_read_b128 v[32:35], v10 offset:2560
    v_exp_f32 v132, v132
    v_exp_f32 v133, v133
    v_exp_f32 v134, v134
    s_waitcnt lgkmcnt(3)
    v_mfma_f32_32x32x16_bf16 v[88:103], v[24:27], v[16:19], v[88:103]
    ds_read_b128 v[24:27], v8 offset:43008
    v_exp_f32 v135, v135
    v_exp_f32 v136, v136
    v_exp_f32 v137, v137
    v_exp_f32 v138, v138
    v_smfmac_f32_32x32x32_bf16 v[56:71], v[36:39], v[128:135], v48
    ds_read_b128 v[36:39], v10 offset:2592
    v_exp_f32 v139, v139
    v_exp_f32 v140, v140
    v_exp_f32 v141, v141
    v_mfma_f32_32x32x16_bf16 v[104:119], v[28:31], v[16:19], v[104:119]
    ds_read_b128 v[28:31], v8 offset:44032
    v_exp_f32 v142, v142
    v_exp_f32 v143, v143
    v_exp_f32 v144, v144
    v_exp_f32 v145, v145
    v_smfmac_f32_32x32x32_bf16 v[56:71], v[40:43], v[136:143], v48
    ds_read_b128 v[40:43], v10 offset:2624
    v_exp_f32 v146, v146
    v_exp_f32 v147, v147
    v_exp_f32 v148, v148
    v_exp_f32 v149, v149
    v_exp_f32 v150, v150
    v_exp_f32 v151, v151
    v_exp_f32 v88, v88
    v_exp_f32 v89, v89
    s_waitcnt lgkmcnt(3)
    v_smfmac_f32_32x32x32_bf16 v[56:71], v[44:47], v[144:151], v48
    ds_read_b128 v[44:47], v10 offset:2656
    v_exp_f32 v90, v90
    v_exp_f32 v91, v91
    v_mfma_f32_32x32x4_2b_bf16 v[120:151], v[22:23], v[20:21], 0
    ds_read_b32 v22, v9 offset:5632
    v_exp_f32 v92, v92
    v_exp_f32 v93, v93
    v_exp_f32 v94, v94
    v_exp_f32 v95, v95
    v_exp_f32 v96, v96
    v_exp_f32 v97, v97
    v_exp_f32 v98, v98
    v_exp_f32 v99, v99
    v_smfmac_f32_32x32x32_bf16 v[56:71], v[32:35], v[88:95], v48
    ds_read_b128 v[32:35], v10 offset:2688
    v_exp_f32 v100, v100
    v_exp_f32 v101, v101
    v_exp_f32 v102, v102
    v_mfma_f32_32x32x16_bf16 v[120:135], v[24:27], v[16:19], v[120:135]
    ds_read_b128 v[24:27], v8 offset:45056
    v_exp_f32 v103, v103
    v_exp_f32 v104, v104
    v_exp_f32 v105, v105
    v_exp_f32 v106, v106
    s_waitcnt lgkmcnt(3)
    v_smfmac_f32_32x32x32_bf16 v[56:71], v[36:39], v[96:103], v48
    ds_read_b128 v[36:39], v10 offset:2720
    v_exp_f32 v107, v107
    v_exp_f32 v108, v108
    v_exp_f32 v109, v109
    v_mfma_f32_32x32x16_bf16 v[136:151], v[28:31], v[16:19], v[136:151]
    ds_read_b128 v[28:31], v8 offset:46080
    v_exp_f32 v110, v110
    v_exp_f32 v111, v111
    v_exp_f32 v112, v112
    v_exp_f32 v113, v113
    v_smfmac_f32_32x32x32_bf16 v[56:71], v[40:43], v[104:111], v48
    ds_read_b128 v[40:43], v10 offset:2752
    v_exp_f32 v114, v114
    v_exp_f32 v115, v115
    v_exp_f32 v116, v116
    v_exp_f32 v117, v117
    v_exp_f32 v118, v118
    v_exp_f32 v119, v119
    v_exp_f32 v120, v120
    v_exp_f32 v121, v121
    v_smfmac_f32_32x32x32_bf16 v[56:71], v[44:47], v[112:119], v48
    ds_read_b128 v[44:47], v10 offset:2784
    v_exp_f32 v122, v122
    v_exp_f32 v123, v123
    s_waitcnt lgkmcnt(3)
    v_mfma_f32_32x32x4_2b_bf16 v[88:119], v[22:23], v[20:21], 0
    ds_read_b32 v22, v9 offset:5888
    v_exp_f32 v124, v124
    v_exp_f32 v125, v125
    v_exp_f32 v126, v126
    v_exp_f32 v127, v127
    v_exp_f32 v128, v128
    v_exp_f32 v129, v129
    v_exp_f32 v130, v130
    v_exp_f32 v131, v131
    v_smfmac_f32_32x32x32_bf16 v[56:71], v[32:35], v[120:127], v48
    ds_read_b128 v[32:35], v10 offset:2816
    v_exp_f32 v132, v132
    v_exp_f32 v133, v133
    v_exp_f32 v134, v134
    v_mfma_f32_32x32x16_bf16 v[88:103], v[24:27], v[16:19], v[88:103]
    ds_read_b128 v[24:27], v8 offset:47104
    v_exp_f32 v135, v135
    v_exp_f32 v136, v136
    v_exp_f32 v137, v137
    v_exp_f32 v138, v138
    v_smfmac_f32_32x32x32_bf16 v[56:71], v[36:39], v[128:135], v48
    ds_read_b128 v[36:39], v10 offset:2848
    v_exp_f32 v139, v139
    v_exp_f32 v140, v140
    v_exp_f32 v141, v141
    s_waitcnt lgkmcnt(3)
    v_mfma_f32_32x32x16_bf16 v[104:119], v[28:31], v[16:19], v[104:119]
    ds_read_b128 v[28:31], v8 offset:48128
    v_exp_f32 v142, v142
    v_exp_f32 v143, v143
    v_exp_f32 v144, v144
    v_exp_f32 v145, v145
    v_smfmac_f32_32x32x32_bf16 v[56:71], v[40:43], v[136:143], v48
    ds_read_b128 v[40:43], v10 offset:2880
    v_exp_f32 v146, v146
    v_exp_f32 v147, v147
    v_exp_f32 v148, v148
    v_exp_f32 v149, v149
    v_exp_f32 v150, v150
    v_exp_f32 v151, v151
    v_exp_f32 v88, v88
    v_exp_f32 v89, v89
    v_smfmac_f32_32x32x32_bf16 v[56:71], v[44:47], v[144:151], v48
    ds_read_b128 v[44:47], v10 offset:2912
    v_exp_f32 v90, v90
    v_exp_f32 v91, v91
    v_mfma_f32_32x32x4_2b_bf16 v[120:151], v[22:23], v[20:21], 0
    ds_read_b32 v22, v9 offset:6144
    v_exp_f32 v92, v92
    v_exp_f32 v93, v93
    v_exp_f32 v94, v94
    v_exp_f32 v95, v95
    s_setprio 0
    v_exp_f32 v96, v96
    v_exp_f32 v97, v97
    v_exp_f32 v98, v98
    v_exp_f32 v99, v99
    s_waitcnt lgkmcnt(3)
    v_smfmac_f32_32x32x32_bf16 v[56:71], v[32:35], v[88:95], v48
    ds_read_b128 v[32:35], v10 offset:2944
    v_exp_f32 v100, v100
    v_exp_f32 v101, v101
    v_exp_f32 v102, v102
    v_mfma_f32_32x32x16_bf16 v[120:135], v[24:27], v[16:19], v[120:135]
    ds_read_b128 v[24:27], v8 offset:49152
    v_exp_f32 v103, v103
    v_exp_f32 v104, v104
    v_exp_f32 v105, v105
    v_exp_f32 v106, v106
    v_smfmac_f32_32x32x32_bf16 v[56:71], v[36:39], v[96:103], v48
    ds_read_b128 v[36:39], v10 offset:2976
    v_exp_f32 v107, v107
    v_exp_f32 v108, v108
    v_exp_f32 v109, v109
    v_mfma_f32_32x32x16_bf16 v[136:151], v[28:31], v[16:19], v[136:151]
    ds_read_b128 v[28:31], v8 offset:50176
    v_exp_f32 v110, v110
    v_exp_f32 v111, v111
    v_exp_f32 v112, v112
    v_exp_f32 v113, v113
    s_waitcnt lgkmcnt(3)
    v_smfmac_f32_32x32x32_bf16 v[56:71], v[40:43], v[104:111], v48
    ds_read_b128 v[40:43], v10 offset:3008
    v_exp_f32 v114, v114
    v_exp_f32 v115, v115
    v_exp_f32 v116, v116
    v_exp_f32 v117, v117
    v_exp_f32 v118, v118
    v_exp_f32 v119, v119
    v_exp_f32 v120, v120
    v_exp_f32 v121, v121
    v_smfmac_f32_32x32x32_bf16 v[56:71], v[44:47], v[112:119], v48
    ds_read_b128 v[44:47], v10 offset:3040
    v_exp_f32 v122, v122
    v_exp_f32 v123, v123
    v_mfma_f32_32x32x4_2b_bf16 v[88:119], v[22:23], v[20:21], 0
    ds_read_b32 v22, v9 offset:6400
    v_exp_f32 v124, v124
    v_exp_f32 v125, v125
    v_exp_f32 v126, v126
    v_exp_f32 v127, v127
    v_exp_f32 v128, v128
    v_exp_f32 v129, v129
    v_exp_f32 v130, v130
    v_exp_f32 v131, v131
    v_smfmac_f32_32x32x32_bf16 v[56:71], v[32:35], v[120:127], v48
    ds_read_b128 v[32:35], v10 offset:3072
    v_exp_f32 v132, v132
    v_exp_f32 v133, v133
    v_exp_f32 v134, v134
    s_waitcnt lgkmcnt(3)
    v_mfma_f32_32x32x16_bf16 v[88:103], v[24:27], v[16:19], v[88:103]
    ds_read_b128 v[24:27], v8 offset:51200
    v_exp_f32 v135, v135
    v_exp_f32 v136, v136
    v_exp_f32 v137, v137
    v_exp_f32 v138, v138
    v_smfmac_f32_32x32x32_bf16 v[56:71], v[36:39], v[128:135], v48
    ds_read_b128 v[36:39], v10 offset:3104
    v_exp_f32 v139, v139
    v_exp_f32 v140, v140
    v_exp_f32 v141, v141
    v_mfma_f32_32x32x16_bf16 v[104:119], v[28:31], v[16:19], v[104:119]
    ds_read_b128 v[28:31], v8 offset:52224
    v_exp_f32 v142, v142
    v_exp_f32 v143, v143
    v_exp_f32 v144, v144
    v_exp_f32 v145, v145
    v_smfmac_f32_32x32x32_bf16 v[56:71], v[40:43], v[136:143], v48
    ds_read_b128 v[40:43], v10 offset:3136
    v_exp_f32 v146, v146
    v_exp_f32 v147, v147
    v_exp_f32 v148, v148
    v_exp_f32 v149, v149
    v_exp_f32 v150, v150
    v_exp_f32 v151, v151
    v_exp_f32 v88, v88
    v_exp_f32 v89, v89
    s_waitcnt lgkmcnt(3)
    v_smfmac_f32_32x32x32_bf16 v[56:71], v[44:47], v[144:151], v48
    ds_read_b128 v[44:47], v10 offset:3168
    v_exp_f32 v90, v90
    v_exp_f32 v91, v91
    v_mfma_f32_32x32x4_2b_bf16 v[120:151], v[22:23], v[20:21], 0
    ds_read_b32 v22, v9 offset:6656
    v_exp_f32 v92, v92
    v_exp_f32 v93, v93
    v_exp_f32 v94, v94
    v_exp_f32 v95, v95
    v_exp_f32 v96, v96
    v_exp_f32 v97, v97
    v_exp_f32 v98, v98
    v_exp_f32 v99, v99
    v_smfmac_f32_32x32x32_bf16 v[56:71], v[32:35], v[88:95], v48
    ds_read_b128 v[32:35], v10 offset:3200
    v_exp_f32 v100, v100
    v_exp_f32 v101, v101
    v_exp_f32 v102, v102
    v_mfma_f32_32x32x16_bf16 v[120:135], v[24:27], v[16:19], v[120:135]
    ds_read_b128 v[24:27], v8 offset:53248
    v_exp_f32 v103, v103
    v_exp_f32 v104, v104
    v_exp_f32 v105, v105
    v_exp_f32 v106, v106
    s_waitcnt lgkmcnt(3)
    v_smfmac_f32_32x32x32_bf16 v[56:71], v[36:39], v[96:103], v48
    ds_read_b128 v[36:39], v10 offset:3232
    v_exp_f32 v107, v107
    v_exp_f32 v108, v108
    v_exp_f32 v109, v109
    v_mfma_f32_32x32x16_bf16 v[136:151], v[28:31], v[16:19], v[136:151]
    ds_read_b128 v[28:31], v8 offset:54272
    v_exp_f32 v110, v110
    v_exp_f32 v111, v111
    v_exp_f32 v112, v112
    v_exp_f32 v113, v113
    v_smfmac_f32_32x32x32_bf16 v[56:71], v[40:43], v[104:111], v48
    ds_read_b128 v[40:43], v10 offset:3264
    v_exp_f32 v114, v114
    v_exp_f32 v115, v115
    v_exp_f32 v116, v116
    v_exp_f32 v117, v117
    v_exp_f32 v118, v118
    v_exp_f32 v119, v119
    v_exp_f32 v120, v120
    v_exp_f32 v121, v121
    v_smfmac_f32_32x32x32_bf16 v[56:71], v[44:47], v[112:119], v48
    ds_read_b128 v[44:47], v10 offset:3296
    v_exp_f32 v122, v122
    v_exp_f32 v123, v123
    s_waitcnt lgkmcnt(3)
    v_mfma_f32_32x32x4_2b_bf16 v[88:119], v[22:23], v[20:21], 0
    ds_read_b32 v22, v9 offset:6912
    buffer_load_dword v161, v5, s[20:23], 0 offen
    v_exp_f32 v124, v124
    v_exp_f32 v125, v125
    v_exp_f32 v126, v126
    v_exp_f32 v127, v127
    v_exp_f32 v128, v128
    v_exp_f32 v129, v129
    v_exp_f32 v130, v130
    v_exp_f32 v131, v131
    v_smfmac_f32_32x32x32_bf16 v[56:71], v[32:35], v[120:127], v48
    ds_read_b128 v[32:35], v10 offset:3328
    v_exp_f32 v132, v132
    v_exp_f32 v133, v133
    v_exp_f32 v134, v134
    v_mfma_f32_32x32x16_bf16 v[88:103], v[24:27], v[16:19], v[88:103]
    ds_read_b128 v[24:27], v8 offset:55296
    v_exp_f32 v135, v135
    v_exp_f32 v136, v136
    v_exp_f32 v137, v137
    v_exp_f32 v138, v138
    v_smfmac_f32_32x32x32_bf16 v[56:71], v[36:39], v[128:135], v48
    ds_read_b128 v[36:39], v10 offset:3360
    v_exp_f32 v139, v139
    v_exp_f32 v140, v140
    v_exp_f32 v141, v141
    s_waitcnt lgkmcnt(3)
    v_mfma_f32_32x32x16_bf16 v[104:119], v[28:31], v[16:19], v[104:119]
    ds_read_b128 v[28:31], v8 offset:56320
    v_exp_f32 v142, v142
    v_exp_f32 v143, v143
    v_exp_f32 v144, v144
    v_exp_f32 v145, v145
    v_smfmac_f32_32x32x32_bf16 v[56:71], v[40:43], v[136:143], v48
    ds_read_b128 v[40:43], v10 offset:3392
    v_exp_f32 v146, v146
    v_exp_f32 v147, v147
    v_exp_f32 v148, v148
    v_exp_f32 v149, v149
    v_exp_f32 v150, v150
    v_exp_f32 v151, v151
    v_exp_f32 v88, v88
    v_exp_f32 v89, v89
    v_smfmac_f32_32x32x32_bf16 v[56:71], v[44:47], v[144:151], v48
    ds_read_b128 v[44:47], v10 offset:3424
    v_exp_f32 v90, v90
    v_exp_f32 v91, v91
    v_mfma_f32_32x32x4_2b_bf16 v[120:151], v[22:23], v[20:21], 0
    ds_read_b32 v22, v9 offset:7168
    v_exp_f32 v92, v92
    v_exp_f32 v93, v93
    v_exp_f32 v94, v94
    v_exp_f32 v95, v95
    v_exp_f32 v96, v96
    v_exp_f32 v97, v97
    v_exp_f32 v98, v98
    v_exp_f32 v99, v99
    s_waitcnt lgkmcnt(3)
    v_smfmac_f32_32x32x32_bf16 v[56:71], v[32:35], v[88:95], v48
    ds_read_b128 v[32:35], v10 offset:3456
    v_exp_f32 v100, v100
    v_exp_f32 v101, v101
    v_exp_f32 v102, v102
    v_mfma_f32_32x32x16_bf16 v[120:135], v[24:27], v[16:19], v[120:135]
    ds_read_b128 v[24:27], v8 offset:57344
    v_exp_f32 v103, v103
    v_exp_f32 v104, v104
    v_exp_f32 v105, v105
    v_exp_f32 v106, v106
    v_smfmac_f32_32x32x32_bf16 v[56:71], v[36:39], v[96:103], v48
    ds_read_b128 v[36:39], v10 offset:3488
    v_exp_f32 v107, v107
    v_exp_f32 v108, v108
    v_exp_f32 v109, v109
    v_mfma_f32_32x32x16_bf16 v[136:151], v[28:31], v[16:19], v[136:151]
    ds_read_b128 v[28:31], v8 offset:58368
    v_exp_f32 v110, v110
    v_exp_f32 v111, v111
    v_exp_f32 v112, v112
    v_exp_f32 v113, v113
    s_waitcnt lgkmcnt(3)
    v_smfmac_f32_32x32x32_bf16 v[56:71], v[40:43], v[104:111], v48
    ds_read_b128 v[40:43], v10 offset:3520
    v_exp_f32 v114, v114
    v_exp_f32 v115, v115
    v_exp_f32 v116, v116
    v_exp_f32 v117, v117
    v_exp_f32 v118, v118
    v_exp_f32 v119, v119
    v_exp_f32 v120, v120
    v_exp_f32 v121, v121
    v_smfmac_f32_32x32x32_bf16 v[56:71], v[44:47], v[112:119], v48
    ds_read_b128 v[44:47], v10 offset:3552
    v_exp_f32 v122, v122
    v_exp_f32 v123, v123
    v_mfma_f32_32x32x4_2b_bf16 v[88:119], v[22:23], v[20:21], 0
    ds_read_b32 v22, v9 offset:7424
    v_exp_f32 v124, v124
    v_exp_f32 v125, v125
    v_exp_f32 v126, v126
    v_exp_f32 v127, v127
    v_exp_f32 v128, v128
    v_exp_f32 v129, v129
    v_exp_f32 v130, v130
    v_exp_f32 v131, v131
    v_smfmac_f32_32x32x32_bf16 v[56:71], v[32:35], v[120:127], v48
    ds_read_b128 v[32:35], v10 offset:3584
    v_exp_f32 v132, v132
    v_exp_f32 v133, v133
    v_exp_f32 v134, v134
    s_waitcnt lgkmcnt(3)
    v_mfma_f32_32x32x16_bf16 v[88:103], v[24:27], v[16:19], v[88:103]
    ds_read_b128 v[24:27], v8 offset:59392
    v_exp_f32 v135, v135
    v_exp_f32 v136, v136
    v_exp_f32 v137, v137
    v_exp_f32 v138, v138
    v_smfmac_f32_32x32x32_bf16 v[56:71], v[36:39], v[128:135], v48
    ds_read_b128 v[36:39], v10 offset:3616
    v_exp_f32 v139, v139
    v_exp_f32 v140, v140
    v_exp_f32 v141, v141
    v_mfma_f32_32x32x16_bf16 v[104:119], v[28:31], v[16:19], v[104:119]
    ds_read_b128 v[28:31], v8 offset:60416
    v_exp_f32 v142, v142
    v_exp_f32 v143, v143
    v_exp_f32 v144, v144
    v_exp_f32 v145, v145
    v_smfmac_f32_32x32x32_bf16 v[56:71], v[40:43], v[136:143], v48
    ds_read_b128 v[40:43], v10 offset:3648
    v_exp_f32 v146, v146
    v_exp_f32 v147, v147
    v_exp_f32 v148, v148
    v_exp_f32 v149, v149
    v_exp_f32 v150, v150
    v_exp_f32 v151, v151
    v_exp_f32 v88, v88
    v_exp_f32 v89, v89
    s_waitcnt lgkmcnt(3)
    v_smfmac_f32_32x32x32_bf16 v[56:71], v[44:47], v[144:151], v48
    ds_read_b128 v[44:47], v10 offset:3680
    v_exp_f32 v90, v90
    v_exp_f32 v91, v91
    v_mfma_f32_32x32x4_2b_bf16 v[120:151], v[22:23], v[20:21], 0
    ds_read_b32 v22, v9 offset:7680
    v_exp_f32 v92, v92
    v_exp_f32 v93, v93
    v_exp_f32 v94, v94
    v_exp_f32 v95, v95
    v_exp_f32 v96, v96
    v_exp_f32 v97, v97
    v_exp_f32 v98, v98
    v_exp_f32 v99, v99
    v_smfmac_f32_32x32x32_bf16 v[56:71], v[32:35], v[88:95], v48
    ds_read_b128 v[32:35], v10 offset:3712
    v_exp_f32 v100, v100
    v_exp_f32 v101, v101
    v_exp_f32 v102, v102
    v_mfma_f32_32x32x16_bf16 v[120:135], v[24:27], v[16:19], v[120:135]
    ds_read_b128 v[24:27], v8 offset:61440
    v_exp_f32 v103, v103
    v_exp_f32 v104, v104
    v_exp_f32 v105, v105
    v_exp_f32 v106, v106
    s_waitcnt lgkmcnt(3)
    v_smfmac_f32_32x32x32_bf16 v[56:71], v[36:39], v[96:103], v48
    ds_read_b128 v[36:39], v10 offset:3744
    v_exp_f32 v107, v107
    v_exp_f32 v108, v108
    v_exp_f32 v109, v109
    v_mfma_f32_32x32x16_bf16 v[136:151], v[28:31], v[16:19], v[136:151]
    ds_read_b128 v[28:31], v8 offset:62464
    v_exp_f32 v110, v110
    v_exp_f32 v111, v111
    v_exp_f32 v112, v112
    v_exp_f32 v113, v113
    v_smfmac_f32_32x32x32_bf16 v[56:71], v[40:43], v[104:111], v48
    ds_read_b128 v[40:43], v10 offset:3776
    v_exp_f32 v114, v114
    v_exp_f32 v115, v115
    v_exp_f32 v116, v116
    v_exp_f32 v117, v117
    v_exp_f32 v118, v118
    v_exp_f32 v119, v119
    v_exp_f32 v120, v120
    v_exp_f32 v121, v121
    v_smfmac_f32_32x32x32_bf16 v[56:71], v[44:47], v[112:119], v48
    ds_read_b128 v[44:47], v10 offset:3808
    v_exp_f32 v122, v122
    v_exp_f32 v123, v123
    s_waitcnt lgkmcnt(3)
    v_mfma_f32_32x32x4_2b_bf16 v[88:119], v[22:23], v[20:21], 0
    ds_read_b32 v22, v9 offset:7936
    v_exp_f32 v124, v124
    v_exp_f32 v125, v125
    v_exp_f32 v126, v126
    v_exp_f32 v127, v127
    v_exp_f32 v128, v128
    v_exp_f32 v129, v129
    v_exp_f32 v130, v130
    v_exp_f32 v131, v131
    v_smfmac_f32_32x32x32_bf16 v[56:71], v[32:35], v[120:127], v48
    ds_read_b128 v[32:35], v10 offset:3840
    v_exp_f32 v132, v132
    v_exp_f32 v133, v133
    v_exp_f32 v134, v134
    v_mfma_f32_32x32x16_bf16 v[88:103], v[24:27], v[16:19], v[88:103]
    ds_read_b128 v[24:27], v8 offset:63488
    v_exp_f32 v135, v135
    v_exp_f32 v136, v136
    v_exp_f32 v137, v137
    v_exp_f32 v138, v138
    v_smfmac_f32_32x32x32_bf16 v[56:71], v[36:39], v[128:135], v48
    ds_read_b128 v[36:39], v10 offset:3872
    v_exp_f32 v139, v139
    v_exp_f32 v140, v140
    v_exp_f32 v141, v141
    s_waitcnt lgkmcnt(3)
    v_mfma_f32_32x32x16_bf16 v[104:119], v[28:31], v[16:19], v[104:119]
    ds_read_b128 v[28:31], v8 offset:64512
    v_exp_f32 v142, v142
    v_exp_f32 v143, v143
    v_exp_f32 v144, v144
    v_exp_f32 v145, v145
    v_smfmac_f32_32x32x32_bf16 v[56:71], v[40:43], v[136:143], v48
    ds_read_b128 v[40:43], v10 offset:3904
    v_exp_f32 v146, v146
    v_exp_f32 v147, v147
    v_exp_f32 v148, v148
    v_exp_f32 v149, v149
    v_exp_f32 v150, v150
    v_exp_f32 v151, v151
    v_exp_f32 v88, v88
    v_exp_f32 v89, v89
    v_smfmac_f32_32x32x32_bf16 v[56:71], v[44:47], v[144:151], v48
    ds_read_b128 v[44:47], v10 offset:3936
    v_exp_f32 v90, v90
    v_exp_f32 v91, v91
    v_mfma_f32_32x32x4_2b_bf16 v[120:151], v[22:23], v[20:21], 0
    v_exp_f32 v92, v92
    v_exp_f32 v93, v93
    v_exp_f32 v94, v94
    v_exp_f32 v95, v95
    v_exp_f32 v96, v96
    v_exp_f32 v97, v97
    v_exp_f32 v98, v98
    v_exp_f32 v99, v99
    s_waitcnt lgkmcnt(3)
    v_smfmac_f32_32x32x32_bf16 v[56:71], v[32:35], v[88:95], v48
    ds_read_b128 v[32:35], v10 offset:3968
    v_exp_f32 v100, v100
    v_exp_f32 v101, v101
    v_exp_f32 v102, v102
    v_mfma_f32_32x32x16_bf16 v[120:135], v[24:27], v[16:19], v[120:135]
    v_exp_f32 v103, v103
    v_exp_f32 v104, v104
    v_exp_f32 v105, v105
    v_exp_f32 v106, v106
    v_smfmac_f32_32x32x32_bf16 v[56:71], v[36:39], v[96:103], v48
    ds_read_b128 v[36:39], v10 offset:4000
    v_exp_f32 v107, v107
    v_exp_f32 v108, v108
    v_exp_f32 v109, v109
    s_waitcnt lgkmcnt(3)
    v_mfma_f32_32x32x16_bf16 v[136:151], v[28:31], v[16:19], v[136:151]
    v_exp_f32 v110, v110
    v_exp_f32 v111, v111
    v_exp_f32 v112, v112
    v_exp_f32 v113, v113
    v_smfmac_f32_32x32x32_bf16 v[56:71], v[40:43], v[104:111], v48
    ds_read_b128 v[40:43], v10 offset:4032
    v_exp_f32 v114, v114
    v_exp_f32 v115, v115
    v_exp_f32 v116, v116
    v_exp_f32 v117, v117
    v_exp_f32 v118, v118
    v_exp_f32 v119, v119
    v_exp_f32 v120, v120
    v_exp_f32 v121, v121
    s_waitcnt lgkmcnt(3)
    v_smfmac_f32_32x32x32_bf16 v[56:71], v[44:47], v[112:119], v48
    ds_read_b128 v[44:47], v10 offset:4064
    v_exp_f32 v122, v122
    v_exp_f32 v123, v123
    v_exp_f32 v124, v124
    v_exp_f32 v125, v125
    v_exp_f32 v126, v126
    v_exp_f32 v127, v127
    v_exp_f32 v128, v128
    v_exp_f32 v129, v129
    v_exp_f32 v130, v130
    v_exp_f32 v131, v131
    s_waitcnt lgkmcnt(3)
    v_smfmac_f32_32x32x32_bf16 v[56:71], v[32:35], v[120:127], v48
    v_exp_f32 v132, v132
    v_exp_f32 v133, v133
    v_exp_f32 v134, v134
    v_exp_f32 v135, v135
    v_exp_f32 v136, v136
    v_exp_f32 v137, v137
    v_exp_f32 v138, v138
    s_waitcnt lgkmcnt(2)
    v_smfmac_f32_32x32x32_bf16 v[56:71], v[36:39], v[128:135], v48
    v_exp_f32 v139, v139
    v_exp_f32 v140, v140
    v_exp_f32 v141, v141
    v_exp_f32 v142, v142
    v_exp_f32 v143, v143
    v_exp_f32 v144, v144
    v_exp_f32 v145, v145
    s_waitcnt lgkmcnt(1)
    v_smfmac_f32_32x32x32_bf16 v[56:71], v[40:43], v[136:143], v48
    v_exp_f32 v146, v146
    v_exp_f32 v147, v147
    v_exp_f32 v148, v148
    v_exp_f32 v149, v149
    v_exp_f32 v150, v150
    v_exp_f32 v151, v151
    s_nop 1
    s_waitcnt lgkmcnt(0)
    v_smfmac_f32_32x32x32_bf16 v[56:71], v[44:47], v[144:151], v48
    s_nop 11
L_final:
    v_rcp_f32 v100, v68
    s_nop 0
    v_pk_mul_f32 v[88:89], v[56:57], v[100:101] op_sel_hi:[1,0]
    v_pk_mul_f32 v[90:91], v[58:59], v[100:101] op_sel_hi:[1,0]
    v_pk_mul_f32 v[92:93], v[60:61], v[100:101] op_sel_hi:[1,0]
    v_pk_mul_f32 v[94:95], v[62:63], v[100:101] op_sel_hi:[1,0]
    v_pk_mul_f32 v[96:97], v[64:65], v[100:101] op_sel_hi:[1,0]
L_store:
    v_cvt_pk_bf16_f32 v104, v88, v89
    v_cvt_pk_bf16_f32 v106, v92, v93
    v_cvt_pk_bf16_f32 v105, v90, v91
    v_cvt_pk_bf16_f32 v107, v94, v95
    v_cvt_pk_bf16_f32 v108, v96, v97
    v_permlane32_swap_b32 v104, v106
    v_permlane32_swap_b32 v105, v107
    s_nop 0
    buffer_store_dwordx4 v[104:107], v5, s[20:23], 0 offen
    s_mov_b32 exec_hi, 0
    buffer_store_dword v108, v13, s[20:23], 0 offen offset:32
    s_mov_b32 exec_hi, -1
    s_cmp_eq_u32 s46, 1
    s_cbranch_scc1 L_done
    v_pk_add_f32 v[110:111], v[88:89], v[90:91]
    v_pk_add_f32 v[112:113], v[92:93], v[94:95]
    v_cmp_le_f32 vcc, 1.0, v68
    v_pk_add_f32 v[110:111], v[110:111], v[96:97]
    s_mov_b32 s47, 0x71800000
    v_pk_add_f32 v[110:111], v[110:111], v[112:113]
    v_cmp_ge_f32 s[40:41], s47, v68
    v_add_f32 v110, v110, v111
    v_sub_f32 v110, v110, v110
    v_cmp_o_f32 s[42:43], v110, v110
    s_nop 1
    s_and_b64 vcc, vcc, s[40:41]
    s_and_b64 vcc, vcc, s[42:43]
    s_andn2_b64 s[40:41], exec, vcc
    s_cbranch_scc1 L_fallback
L_done:
L_end:
    s_endpgm
L_loader:
    s_sub_u32 s49, s24, 8
    s_mul_i32 s56, s49, 5120
    s_add_u32 s56, s56, 152576
    s_mul_i32 s58, s49, 4096
    s_mul_i32 s57, s49, 8192
    s_add_u32 s57, s57, 49152
    s_waitcnt lgkmcnt(0)
    s_add_u32 s12, s28, s27
    s_addc_u32 s13, s29, 0
    s_mul_i32 s50, s49, 4096
    s_mul_i32 s51, s49, 4608
    s_mul_i32 s52, s49, 1024
    s_add_u32 s52, s52, 65536
    s_mul_i32 s53, s49, 9216
    s_mul_i32 s54, s49, 512
    s_add_u32 s54, s54, 66560
    s_mul_i32 s55, s49, 4608
    s_add_u32 s55, s55, 9216
    s_mul_i32 s59, s49, 9216
    s_add_u32 s8, s6, s27
    s_addc_u32 s9, s7, 0
    s_lshl_b32 s40, s49, 9
    s_add_u32 s40, s40, s56
    s_mul_i32 s41, s49, 256
    s_add_u32 s41, s41, 73728
    v_bfe_u32 v3, v2, 2, 2
    v_and_b32 v7, 3, v2
    v_lshlrev_b32 v6, 3, v4
    v_add_u32 v3, v3, v6
    v_mul_u32_u24 v3, 72, v3
    v_add_u32 v3, s40, v3
    v_cmp_eq_u32 vcc, 1, v14
    v_lshlrev_b32 v6, 3, v7
    v_add_u32 v64, v3, v6
    v_add_u32 v65, 40, v64
    v_add_u32 v3, 32, v3
    v_cndmask_b32 v64, v64, v3, vcc
    v_cndmask_b32 v65, v65, v3, vcc
    v_and_b32 v3, 31, v2
    v_add_u32 v6, 2, v3
    v_add_u32 v7, -18, v3
    v_and_b32 v7, 1, v7
    v_lshlrev_b32 v1, 4, v4
    v_cndmask_b32 v6, v6, v7, vcc
    v_add_u32 v1, s41, v1
    v_mul_u32_u24 v3, 4112, v3
    v_mul_u32_u24 v6, 4112, v6
    v_add_u32 v68, v3, v1
    v_add3_u32 v69, v6, v1, 32
    s_sub_u32 s40, s57, s56
    v_add_u32 v66, s40, v64
    v_add_u32 v67, s40, v65
    s_mul_i32 s40, s49, 2
    s_add_u32 s40, s40, 163836
    v_mov_b32 v163, s40
    v_mov_b32 v162, 0x8000
    ds_write_b16 v163, v162
    s_mov_b32 s40, 0x3ffff
    s_mov_b32 s41, 0x3ffff
    s_mov_b32 s42, 0xcffff
    s_mov_b32 s43, 0xcffff
    s_add_u32 m0, s57, 0
    s_add_u32 s32, s58, 9216
    buffer_load_dwordx4 v154, s[12:15], s32 offen lds
    s_add_u32 m0, s57, 1024
    s_add_u32 s32, s58, 10240
    buffer_load_dwordx4 v154, s[12:15], s32 offen lds
    s_add_u32 m0, s57, 2048
    s_add_u32 s32, s58, 11264
    buffer_load_dwordx4 v154, s[12:15], s32 offen lds
    s_add_u32 m0, s57, 3072
    s_add_u32 s32, s58, 12288
    buffer_load_dwordx4 v154, s[12:15], s32 offen lds
    s_add_u32 m0, s57, 4096
    s_add_u32 s32, s58, 13312
    buffer_load_dwordx4 v154, s[12:15], s32 offen lds
    s_waitcnt lgkmcnt(0)
    s_setprio 3
    s_barrier
    s_add_u32 m0, s54, 0
    s_add_u32 s32, s55, 0
    buffer_load_dword v153, s[8:11], s32 offen lds
    s_add_u32 m0, s54, 256
    s_add_u32 s32, s55, 2304
    buffer_load_dword v153, s[8:11], s32 offen lds
    s_add_u32 m0, s50, 8192
    s_add_u32 s32, s51, 9216
    buffer_load_dwordx4 v152, s[8:11], s32 offen lds
    s_add_u32 m0, s50, 9216
    s_add_u32 s32, s51, 10368
    buffer_load_dwordx4 v152, s[8:11], s32 offen lds
    s_add_u32 m0, s50, 10240
    s_add_u32 s32, s51, 11520
    buffer_load_dwordx4 v152, s[8:11], s32 offen lds
    s_add_u32 m0, s50, 11264
    s_add_u32 s32, s51, 12672
    buffer_load_dwordx4 v152, s[8:11], s32 offen lds
    s_setprio 3
    ds_read_b64_tr_b16 v[16:17], v64 offset:0
    ds_read_b64_tr_b16 v[18:19], v64 offset:288
    ds_read_b64_tr_b16 v[20:21], v65 offset:0
    ds_read_b64_tr_b16 v[22:23], v65 offset:288
    ds_read_b64_tr_b16 v[24:25], v64 offset:1152
    ds_read_b64_tr_b16 v[26:27], v64 offset:1440
    ds_read_b64_tr_b16 v[28:29], v65 offset:1152
    ds_read_b64_tr_b16 v[30:31], v65 offset:1440
    ds_read_b64_tr_b16 v[32:33], v64 offset:2304
    ds_read_b64_tr_b16 v[34:35], v64 offset:2592
    ds_read_b64_tr_b16 v[36:37], v65 offset:2304
    ds_read_b64_tr_b16 v[38:39], v65 offset:2592
    s_waitcnt lgkmcnt(8)
    s_mov_b64 exec, s[40:41]
    ds_write_b128 v68, v[16:19] offset:0
    s_mov_b64 exec, s[42:43]
    ds_write_b128 v69, v[20:23] offset:0
    s_mov_b64 exec, -1
    ds_read_b64_tr_b16 v[40:41], v64 offset:3456
    ds_read_b64_tr_b16 v[42:43], v64 offset:3744
    ds_read_b64_tr_b16 v[44:45], v65 offset:3456
    ds_read_b64_tr_b16 v[46:47], v65 offset:3744
    s_waitcnt lgkmcnt(10)
    s_mov_b64 exec, s[40:41]
    ds_write_b128 v68, v[24:27] offset:64
    s_mov_b64 exec, s[42:43]
    ds_write_b128 v69, v[28:31] offset:64
    s_mov_b64 exec, -1
    s_waitcnt lgkmcnt(8)
    s_mov_b64 exec, s[40:41]
    ds_write_b128 v68, v[32:35] offset:128
    s_mov_b64 exec, s[42:43]
    ds_write_b128 v69, v[36:39] offset:128
    s_mov_b64 exec, -1
    s_waitcnt lgkmcnt(4)
    s_mov_b64 exec, s[40:41]
    ds_write_b128 v68, v[40:43] offset:192
    s_mov_b64 exec, s[42:43]
    ds_write_b128 v69, v[44:47] offset:192
    s_mov_b64 exec, -1
    s_waitcnt lgkmcnt(0)
    s_setprio 3
    v_mov_b32 v162, 0x8001
    ds_write_b16 v163, v162
    s_add_u32 m0, s56, 0
    s_add_u32 s32, s58, 18432
    buffer_load_dwordx4 v154, s[12:15], s32 offen lds
    s_add_u32 m0, s56, 1024
    s_add_u32 s32, s58, 19456
    buffer_load_dwordx4 v154, s[12:15], s32 offen lds
    s_add_u32 m0, s56, 2048
    s_add_u32 s32, s58, 20480
    buffer_load_dwordx4 v154, s[12:15], s32 offen lds
    s_add_u32 m0, s56, 3072
    s_add_u32 s32, s58, 21504
    buffer_load_dwordx4 v154, s[12:15], s32 offen lds
    s_add_u32 m0, s56, 4096
    s_add_u32 s32, s58, 22528
    buffer_load_dwordx4 v154, s[12:15], s32 offen lds
    s_waitcnt vmcnt(11)
    s_setprio 1
    ds_read_b64_tr_b16 v[16:17], v66 offset:0
    ds_read_b64_tr_b16 v[18:19], v66 offset:288
    ds_read_b64_tr_b16 v[20:21], v67 offset:0
    ds_read_b64_tr_b16 v[22:23], v67 offset:288
    ds_read_b64_tr_b16 v[24:25], v66 offset:1152
    ds_read_b64_tr_b16 v[26:27], v66 offset:1440
    ds_read_b64_tr_b16 v[28:29], v67 offset:1152
    ds_read_b64_tr_b16 v[30:31], v67 offset:1440
    ds_read_b64_tr_b16 v[32:33], v66 offset:2304
    ds_read_b64_tr_b16 v[34:35], v66 offset:2592
    ds_read_b64_tr_b16 v[36:37], v67 offset:2304
    ds_read_b64_tr_b16 v[38:39], v67 offset:2592
    s_waitcnt lgkmcnt(8)
    s_mov_b64 exec, s[40:41]
    ds_write_b128 v68, v[16:19] offset:512
    s_mov_b64 exec, s[42:43]
    ds_write_b128 v69, v[20:23] offset:512
    s_mov_b64 exec, -1
    ds_read_b64_tr_b16 v[40:41], v66 offset:3456
    ds_read_b64_tr_b16 v[42:43], v66 offset:3744
    ds_read_b64_tr_b16 v[44:45], v67 offset:3456
    ds_read_b64_tr_b16 v[46:47], v67 offset:3744
    s_waitcnt lgkmcnt(10)
    s_mov_b64 exec, s[40:41]
    ds_write_b128 v68, v[24:27] offset:576
    s_mov_b64 exec, s[42:43]
    ds_write_b128 v69, v[28:31] offset:576
    s_mov_b64 exec, -1
    s_waitcnt lgkmcnt(8)
    s_mov_b64 exec, s[40:41]
    ds_write_b128 v68, v[32:35] offset:640
    s_mov_b64 exec, s[42:43]
    ds_write_b128 v69, v[36:39] offset:640
    s_mov_b64 exec, -1
    s_waitcnt lgkmcnt(4)
    s_mov_b64 exec, s[40:41]
    ds_write_b128 v68, v[40:43] offset:704
    s_mov_b64 exec, s[42:43]
    ds_write_b128 v69, v[44:47] offset:704
    s_mov_b64 exec, -1
    s_waitcnt lgkmcnt(0)
    s_setprio 3
    s_waitcnt vmcnt(5)
    v_mov_b32 v162, 0x8002
    ds_write_b16 v163, v162
    s_add_u32 m0, s57, 0
    s_add_u32 s32, s58, 27648
    buffer_load_dwordx4 v154, s[12:15], s32 offen lds
    s_add_u32 m0, s57, 1024
    s_add_u32 s32, s58, 28672
    buffer_load_dwordx4 v154, s[12:15], s32 offen lds
    s_add_u32 m0, s57, 2048
    s_add_u32 s32, s58, 29696
    buffer_load_dwordx4 v154, s[12:15], s32 offen lds
    s_add_u32 m0, s57, 3072
    s_add_u32 s32, s58, 30720
    buffer_load_dwordx4 v154, s[12:15], s32 offen lds
    s_add_u32 m0, s57, 4096
    s_add_u32 s32, s58, 31744
    buffer_load_dwordx4 v154, s[12:15], s32 offen lds
    s_add_u32 m0, s50, 16384
    s_add_u32 s32, s51, 18432
    buffer_load_dwordx4 v152, s[8:11], s32 offen lds
    s_add_u32 m0, s50, 17408
    s_add_u32 s32, s51, 19584
    buffer_load_dwordx4 v152, s[8:11], s32 offen lds
    s_add_u32 m0, s50, 18432
    s_add_u32 s32, s51, 20736
    buffer_load_dwordx4 v152, s[8:11], s32 offen lds
    s_add_u32 m0, s50, 19456
    s_add_u32 s32, s51, 21888
    buffer_load_dwordx4 v152, s[8:11], s32 offen lds
    s_add_u32 m0, s52, 2048
    s_add_u32 s32, s53, 18432
    buffer_load_dword v153, s[8:11], s32 offen lds
    s_add_u32 m0, s52, 2304
    s_add_u32 s32, s53, 20736
    buffer_load_dword v153, s[8:11], s32 offen lds
    s_add_u32 m0, s52, 2560
    s_add_u32 s32, s53, 23040
    buffer_load_dword v153, s[8:11], s32 offen lds
    s_add_u32 m0, s52, 2816
    s_add_u32 s32, s53, 25344
    buffer_load_dword v153, s[8:11], s32 offen lds
    s_add_u32 m0, s50, 24576
    s_add_u32 s32, s51, 27648
    buffer_load_dwordx4 v152, s[8:11], s32 offen lds
    s_add_u32 m0, s50, 25600
    s_add_u32 s32, s51, 28800
    buffer_load_dwordx4 v152, s[8:11], s32 offen lds
    s_add_u32 m0, s50, 26624
    s_add_u32 s32, s51, 29952
    buffer_load_dwordx4 v152, s[8:11], s32 offen lds
    s_add_u32 m0, s50, 27648
    s_add_u32 s32, s51, 31104
    buffer_load_dwordx4 v152, s[8:11], s32 offen lds
    s_waitcnt vmcnt(17)
    s_setprio 0
    ds_read_b64_tr_b16 v[16:17], v64 offset:0
    ds_read_b64_tr_b16 v[18:19], v64 offset:288
    ds_read_b64_tr_b16 v[20:21], v65 offset:0
    ds_read_b64_tr_b16 v[22:23], v65 offset:288
    ds_read_b64_tr_b16 v[24:25], v64 offset:1152
    ds_read_b64_tr_b16 v[26:27], v64 offset:1440
    ds_read_b64_tr_b16 v[28:29], v65 offset:1152
    ds_read_b64_tr_b16 v[30:31], v65 offset:1440
    ds_read_b64_tr_b16 v[32:33], v64 offset:2304
    ds_read_b64_tr_b16 v[34:35], v64 offset:2592
    ds_read_b64_tr_b16 v[36:37], v65 offset:2304
    ds_read_b64_tr_b16 v[38:39], v65 offset:2592
    s_waitcnt lgkmcnt(8)
    s_mov_b64 exec, s[40:41]
    ds_write_b128 v68, v[16:19] offset:1024
    s_mov_b64 exec, s[42:43]
    ds_write_b128 v69, v[20:23] offset:1024
    s_mov_b64 exec, -1
    ds_read_b64_tr_b16 v[40:41], v64 offset:3456
    ds_read_b64_tr_b16 v[42:43], v64 offset:3744
    ds_read_b64_tr_b16 v[44:45], v65 offset:3456
    ds_read_b64_tr_b16 v[46:47], v65 offset:3744
    s_waitcnt lgkmcnt(10)
    s_mov_b64 exec, s[40:41]
    ds_write_b128 v68, v[24:27] offset:1088
    s_mov_b64 exec, s[42:43]
    ds_write_b128 v69, v[28:31] offset:1088
    s_mov_b64 exec, -1
    s_waitcnt lgkmcnt(8)
    s_mov_b64 exec, s[40:41]
    ds_write_b128 v68, v[32:35] offset:1152
    s_mov_b64 exec, s[42:43]
    ds_write_b128 v69, v[36:39] offset:1152
    s_mov_b64 exec, -1
    s_waitcnt lgkmcnt(4)
    s_mov_b64 exec, s[40:41]
    ds_write_b128 v68, v[40:43] offset:1216
    s_mov_b64 exec, s[42:43]
    ds_write_b128 v69, v[44:47] offset:1216
    s_mov_b64 exec, -1
    s_waitcnt lgkmcnt(0)
    s_setprio 3
    s_add_u32 m0, s56, 0
    s_add_u32 s32, s58, 36864
    buffer_load_dwordx4 v154, s[12:15], s32 offen lds
    s_add_u32 m0, s56, 1024
    s_add_u32 s32, s58, 37888
    buffer_load_dwordx4 v154, s[12:15], s32 offen lds
    s_add_u32 m0, s56, 2048
    s_add_u32 s32, s58, 38912
    buffer_load_dwordx4 v154, s[12:15], s32 offen lds
    s_add_u32 m0, s56, 3072
    s_add_u32 s32, s58, 39936
    buffer_load_dwordx4 v154, s[12:15], s32 offen lds
    s_add_u32 m0, s56, 4096
    s_add_u32 s32, s58, 40960
    buffer_load_dwordx4 v154, s[12:15], s32 offen lds
    s_waitcnt vmcnt(17)
    s_setprio 0
    ds_read_b64_tr_b16 v[16:17], v66 offset:0
    ds_read_b64_tr_b16 v[18:19], v66 offset:288
    ds_read_b64_tr_b16 v[20:21], v67 offset:0
    ds_read_b64_tr_b16 v[22:23], v67 offset:288
    ds_read_b64_tr_b16 v[24:25], v66 offset:1152
    ds_read_b64_tr_b16 v[26:27], v66 offset:1440
    ds_read_b64_tr_b16 v[28:29], v67 offset:1152
    ds_read_b64_tr_b16 v[30:31], v67 offset:1440
    ds_read_b64_tr_b16 v[32:33], v66 offset:2304
    ds_read_b64_tr_b16 v[34:35], v66 offset:2592
    ds_read_b64_tr_b16 v[36:37], v67 offset:2304
    ds_read_b64_tr_b16 v[38:39], v67 offset:2592
    s_waitcnt lgkmcnt(8)
    s_mov_b64 exec, s[40:41]
    ds_write_b128 v68, v[16:19] offset:1536
    s_mov_b64 exec, s[42:43]
    ds_write_b128 v69, v[20:23] offset:1536
    s_mov_b64 exec, -1
    ds_read_b64_tr_b16 v[40:41], v66 offset:3456
    ds_read_b64_tr_b16 v[42:43], v66 offset:3744
    ds_read_b64_tr_b16 v[44:45], v67 offset:3456
    ds_read_b64_tr_b16 v[46:47], v67 offset:3744
    s_waitcnt lgkmcnt(10)
    s_mov_b64 exec, s[40:41]
    ds_write_b128 v68, v[24:27] offset:1600
    s_mov_b64 exec, s[42:43]
    ds_write_b128 v69, v[28:31] offset:1600
    s_mov_b64 exec, -1
    s_waitcnt lgkmcnt(8)
    s_mov_b64 exec, s[40:41]
    ds_write_b128 v68, v[32:35] offset:1664
    s_mov_b64 exec, s[42:43]
    ds_write_b128 v69, v[36:39] offset:1664
    s_mov_b64 exec, -1
    s_waitcnt lgkmcnt(4)
    s_mov_b64 exec, s[40:41]
    ds_write_b128 v68, v[40:43] offset:1728
    s_mov_b64 exec, s[42:43]
    ds_write_b128 v69, v[44:47] offset:1728
    s_mov_b64 exec, -1
    s_waitcnt lgkmcnt(0)
    s_setprio 3
    s_waitcnt vmcnt(5)
    v_mov_b32 v162, 0x8003
    ds_write_b16 v163, v162
    s_add_u32 m0, s57, 0
    s_add_u32 s32, s58, 46080
    buffer_load_dwordx4 v154, s[12:15], s32 offen lds
    s_add_u32 m0, s57, 1024
    s_add_u32 s32, s58, 47104
    buffer_load_dwordx4 v154, s[12:15], s32 offen lds
    s_add_u32 m0, s57, 2048
    s_add_u32 s32, s58, 48128
    buffer_load_dwordx4 v154, s[12:15], s32 offen lds
    s_add_u32 m0, s57, 3072
    s_add_u32 s32, s58, 49152
    buffer_load_dwordx4 v154, s[12:15], s32 offen lds
    s_add_u32 m0, s57, 4096
    s_add_u32 s32, s58, 50176
    buffer_load_dwordx4 v154, s[12:15], s32 offen lds
    s_add_u32 m0, s50, 32768
    s_add_u32 s32, s51, 36864
    buffer_load_dwordx4 v152, s[8:11], s32 offen lds
    s_add_u32 m0, s50, 33792
    s_add_u32 s32, s51, 38016
    buffer_load_dwordx4 v152, s[8:11], s32 offen lds
    s_add_u32 m0, s50, 34816
    s_add_u32 s32, s51, 39168
    buffer_load_dwordx4 v152, s[8:11], s32 offen lds
    s_add_u32 m0, s50, 35840
    s_add_u32 s32, s51, 40320
    buffer_load_dwordx4 v152, s[8:11], s32 offen lds
    s_add_u32 m0, s52, 4096
    s_add_u32 s32, s53, 36864
    buffer_load_dword v153, s[8:11], s32 offen lds
    s_add_u32 m0, s52, 4352
    s_add_u32 s32, s53, 39168
    buffer_load_dword v153, s[8:11], s32 offen lds
    s_add_u32 m0, s52, 4608
    s_add_u32 s32, s53, 41472
    buffer_load_dword v153, s[8:11], s32 offen lds
    s_add_u32 m0, s52, 4864
    s_add_u32 s32, s53, 43776
    buffer_load_dword v153, s[8:11], s32 offen lds
    s_waitcnt vmcnt(13)
    s_setprio 0
    ds_read_b64_tr_b16 v[16:17], v64 offset:0
    ds_read_b64_tr_b16 v[18:19], v64 offset:288
    ds_read_b64_tr_b16 v[20:21], v65 offset:0
    ds_read_b64_tr_b16 v[22:23], v65 offset:288
    ds_read_b64_tr_b16 v[24:25], v64 offset:1152
    ds_read_b64_tr_b16 v[26:27], v64 offset:1440
    ds_read_b64_tr_b16 v[28:29], v65 offset:1152
    ds_read_b64_tr_b16 v[30:31], v65 offset:1440
    ds_read_b64_tr_b16 v[32:33], v64 offset:2304
    ds_read_b64_tr_b16 v[34:35], v64 offset:2592
    ds_read_b64_tr_b16 v[36:37], v65 offset:2304
    ds_read_b64_tr_b16 v[38:39], v65 offset:2592
    s_waitcnt lgkmcnt(8)
    s_mov_b64 exec, s[40:41]
    ds_write_b128 v68, v[16:19] offset:2048
    s_mov_b64 exec, s[42:43]
    ds_write_b128 v69, v[20:23] offset:2048
    s_mov_b64 exec, -1
    ds_read_b64_tr_b16 v[40:41], v64 offset:3456
    ds_read_b64_tr_b16 v[42:43], v64 offset:3744
    ds_read_b64_tr_b16 v[44:45], v65 offset:3456
    ds_read_b64_tr_b16 v[46:47], v65 offset:3744
    s_waitcnt lgkmcnt(10)
    s_mov_b64 exec, s[40:41]
    ds_write_b128 v68, v[24:27] offset:2112
    s_mov_b64 exec, s[42:43]
    ds_write_b128 v69, v[28:31] offset:2112
    s_mov_b64 exec, -1
    s_waitcnt lgkmcnt(8)
    s_mov_b64 exec, s[40:41]
    ds_write_b128 v68, v[32:35] offset:2176
    s_mov_b64 exec, s[42:43]
    ds_write_b128 v69, v[36:39] offset:2176
    s_mov_b64 exec, -1
    s_waitcnt lgkmcnt(4)
    s_mov_b64 exec, s[40:41]
    ds_write_b128 v68, v[40:43] offset:2240
    s_mov_b64 exec, s[42:43]
    ds_write_b128 v69, v[44:47] offset:2240
    s_mov_b64 exec, -1
    s_waitcnt lgkmcnt(0)
    s_setprio 3
    s_add_u32 m0, s56, 0
    s_add_u32 s32, s58, 55296
    buffer_load_dwordx4 v154, s[12:15], s32 offen lds
    s_add_u32 m0, s56, 1024
    s_add_u32 s32, s58, 56320
    buffer_load_dwordx4 v154, s[12:15], s32 offen lds
    s_add_u32 m0, s56, 2048
    s_add_u32 s32, s58, 57344
    buffer_load_dwordx4 v154, s[12:15], s32 offen lds
    s_add_u32 m0, s56, 3072
    s_add_u32 s32, s58, 58368
    buffer_load_dwordx4 v154, s[12:15], s32 offen lds
    s_add_u32 m0, s56, 4096
    s_add_u32 s32, s58, 59392
    buffer_load_dwordx4 v154, s[12:15], s32 offen lds
    s_add_u32 m0, s50, 40960
    s_add_u32 s32, s51, 46080
    buffer_load_dwordx4 v152, s[8:11], s32 offen lds
    s_add_u32 m0, s50, 41984
    s_add_u32 s32, s51, 47232
    buffer_load_dwordx4 v152, s[8:11], s32 offen lds
    s_add_u32 m0, s50, 43008
    s_add_u32 s32, s51, 48384
    buffer_load_dwordx4 v152, s[8:11], s32 offen lds
    s_add_u32 m0, s50, 44032
    s_add_u32 s32, s51, 49536
    buffer_load_dwordx4 v152, s[8:11], s32 offen lds
    s_waitcnt vmcnt(17)
    s_setprio 0
    ds_read_b64_tr_b16 v[16:17], v66 offset:0
    ds_read_b64_tr_b16 v[18:19], v66 offset:288
    ds_read_b64_tr_b16 v[20:21], v67 offset:0
    ds_read_b64_tr_b16 v[22:23], v67 offset:288
    ds_read_b64_tr_b16 v[24:25], v66 offset:1152
    ds_read_b64_tr_b16 v[26:27], v66 offset:1440
    ds_read_b64_tr_b16 v[28:29], v67 offset:1152
    ds_read_b64_tr_b16 v[30:31], v67 offset:1440
    ds_read_b64_tr_b16 v[32:33], v66 offset:2304
    ds_read_b64_tr_b16 v[34:35], v66 offset:2592
    ds_read_b64_tr_b16 v[36:37], v67 offset:2304
    ds_read_b64_tr_b16 v[38:39], v67 offset:2592
    s_waitcnt lgkmcnt(8)
    s_mov_b64 exec, s[40:41]
    ds_write_b128 v68, v[16:19] offset:2560
    s_mov_b64 exec, s[42:43]
    ds_write_b128 v69, v[20:23] offset:2560
    s_mov_b64 exec, -1
    ds_read_b64_tr_b16 v[40:41], v66 offset:3456
    ds_read_b64_tr_b16 v[42:43], v66 offset:3744
    ds_read_b64_tr_b16 v[44:45], v67 offset:3456
    ds_read_b64_tr_b16 v[46:47], v67 offset:3744
    s_waitcnt lgkmcnt(10)
    s_mov_b64 exec, s[40:41]
    ds_write_b128 v68, v[24:27] offset:2624
    s_mov_b64 exec, s[42:43]
    ds_write_b128 v69, v[28:31] offset:2624
    s_mov_b64 exec, -1
    s_waitcnt lgkmcnt(8)
    s_mov_b64 exec, s[40:41]
    ds_write_b128 v68, v[32:35] offset:2688
    s_mov_b64 exec, s[42:43]
    ds_write_b128 v69, v[36:39] offset:2688
    s_mov_b64 exec, -1
    s_waitcnt lgkmcnt(4)
    s_mov_b64 exec, s[40:41]
    ds_write_b128 v68, v[40:43] offset:2752
    s_mov_b64 exec, s[42:43]
    ds_write_b128 v69, v[44:47] offset:2752
    s_mov_b64 exec, -1
    s_waitcnt lgkmcnt(0)
    s_setprio 3
    s_add_u32 m0, s57, 0
    s_add_u32 s32, s58, 64512
    buffer_load_dwordx4 v154, s[12:15], s32 offen lds
    s_add_u32 m0, s57, 1024
    s_add_u32 s32, s58, 65536
    buffer_load_dwordx4 v154, s[12:15], s32 offen lds
    s_add_u32 m0, s57, 2048
    s_add_u32 s32, s58, 66560
    buffer_load_dwordx4 v154, s[12:15], s32 offen lds
    s_add_u32 m0, s57, 3072
    s_add_u32 s32, s58, 67584
    buffer_load_dwordx4 v154, s[12:15], s32 offen lds
    s_add_u32 m0, s57, 4096
    s_add_u32 s32, s58, 68608
    buffer_load_dwordx4 v154, s[12:15], s32 offen lds
    s_add_u32 m0, s52, 6144
    s_add_u32 s32, s53, 55296
    buffer_load_dword v153, s[8:11], s32 offen lds
    s_add_u32 m0, s52, 6400
    s_add_u32 s32, s53, 57600
    buffer_load_dword v153, s[8:11], s32 offen lds
    s_add_u32 m0, s52, 6656
    s_add_u32 s32, s53, 59904
    buffer_load_dword v153, s[8:11], s32 offen lds
    s_add_u32 m0, s52, 6912
    s_add_u32 s32, s53, 62208
    buffer_load_dword v153, s[8:11], s32 offen lds
    s_waitcnt vmcnt(13)
    s_setprio 0
    ds_read_b64_tr_b16 v[16:17], v64 offset:0
    ds_read_b64_tr_b16 v[18:19], v64 offset:288
    ds_read_b64_tr_b16 v[20:21], v65 offset:0
    ds_read_b64_tr_b16 v[22:23], v65 offset:288
    ds_read_b64_tr_b16 v[24:25], v64 offset:1152
    ds_read_b64_tr_b16 v[26:27], v64 offset:1440
    ds_read_b64_tr_b16 v[28:29], v65 offset:1152
    ds_read_b64_tr_b16 v[30:31], v65 offset:1440
    ds_read_b64_tr_b16 v[32:33], v64 offset:2304
    ds_read_b64_tr_b16 v[34:35], v64 offset:2592
    ds_read_b64_tr_b16 v[36:37], v65 offset:2304
    ds_read_b64_tr_b16 v[38:39], v65 offset:2592
    s_waitcnt lgkmcnt(8)
    s_mov_b64 exec, s[40:41]
    ds_write_b128 v68, v[16:19] offset:3072
    s_mov_b64 exec, s[42:43]
    ds_write_b128 v69, v[20:23] offset:3072
    s_mov_b64 exec, -1
    ds_read_b64_tr_b16 v[40:41], v64 offset:3456
    ds_read_b64_tr_b16 v[42:43], v64 offset:3744
    ds_read_b64_tr_b16 v[44:45], v65 offset:3456
    ds_read_b64_tr_b16 v[46:47], v65 offset:3744
    s_waitcnt lgkmcnt(10)
    s_mov_b64 exec, s[40:41]
    ds_write_b128 v68, v[24:27] offset:3136
    s_mov_b64 exec, s[42:43]
    ds_write_b128 v69, v[28:31] offset:3136
    s_mov_b64 exec, -1
    s_waitcnt lgkmcnt(8)
    s_mov_b64 exec, s[40:41]
    ds_write_b128 v68, v[32:35] offset:3200
    s_mov_b64 exec, s[42:43]
    ds_write_b128 v69, v[36:39] offset:3200
    s_mov_b64 exec, -1
    s_waitcnt lgkmcnt(4)
    s_mov_b64 exec, s[40:41]
    ds_write_b128 v68, v[40:43] offset:3264
    s_mov_b64 exec, s[42:43]
    ds_write_b128 v69, v[44:47] offset:3264
    s_mov_b64 exec, -1
    s_waitcnt lgkmcnt(0)
    s_setprio 3
    s_waitcnt vmcnt(4)
    s_setprio 0
    ds_read_b64_tr_b16 v[16:17], v66 offset:0
    ds_read_b64_tr_b16 v[18:19], v66 offset:288
    ds_read_b64_tr_b16 v[20:21], v67 offset:0
    ds_read_b64_tr_b16 v[22:23], v67 offset:288
    ds_read_b64_tr_b16 v[24:25], v66 offset:1152
    ds_read_b64_tr_b16 v[26:27], v66 offset:1440
    ds_read_b64_tr_b16 v[28:29], v67 offset:1152
    ds_read_b64_tr_b16 v[30:31], v67 offset:1440
    ds_read_b64_tr_b16 v[32:33], v66 offset:2304
    ds_read_b64_tr_b16 v[34:35], v66 offset:2592
    ds_read_b64_tr_b16 v[36:37], v67 offset:2304
    ds_read_b64_tr_b16 v[38:39], v67 offset:2592
    s_waitcnt lgkmcnt(8)
    s_mov_b64 exec, s[40:41]
    ds_write_b128 v68, v[16:19] offset:3584
    s_mov_b64 exec, s[42:43]
    ds_write_b128 v69, v[20:23] offset:3584
    s_mov_b64 exec, -1
    ds_read_b64_tr_b16 v[40:41], v66 offset:3456
    ds_read_b64_tr_b16 v[42:43], v66 offset:3744
    ds_read_b64_tr_b16 v[44:45], v67 offset:3456
    ds_read_b64_tr_b16 v[46:47], v67 offset:3744
    s_waitcnt lgkmcnt(10)
    s_mov_b64 exec, s[40:41]
    ds_write_b128 v68, v[24:27] offset:3648
    s_mov_b64 exec, s[42:43]
    ds_write_b128 v69, v[28:31] offset:3648
    s_mov_b64 exec, -1
    s_waitcnt lgkmcnt(8)
    s_mov_b64 exec, s[40:41]
    ds_write_b128 v68, v[32:35] offset:3712
    s_mov_b64 exec, s[42:43]
    ds_write_b128 v69, v[36:39] offset:3712
    s_mov_b64 exec, -1
    s_waitcnt lgkmcnt(4)
    s_mov_b64 exec, s[40:41]
    ds_write_b128 v68, v[40:43] offset:3776
    s_mov_b64 exec, s[42:43]
    ds_write_b128 v69, v[44:47] offset:3776
    s_mov_b64 exec, -1
    s_waitcnt lgkmcnt(0)
    s_setprio 3
    s_add_u32 m0, s57, 0
    s_add_u32 s32, s59, 55296
    buffer_load_dwordx4 v152, s[8:11], s32 offen lds
    s_add_u32 m0, s57, 1024
    s_add_u32 s32, s59, 56448
    buffer_load_dwordx4 v152, s[8:11], s32 offen lds
    s_add_u32 m0, s57, 2048
    s_add_u32 s32, s59, 57600
    buffer_load_dwordx4 v152, s[8:11], s32 offen lds
    s_add_u32 m0, s57, 3072
    s_add_u32 s32, s59, 58752
    buffer_load_dwordx4 v152, s[8:11], s32 offen lds
    s_add_u32 m0, s57, 4096
    s_add_u32 s32, s59, 59904
    buffer_load_dwordx4 v152, s[8:11], s32 offen lds
    s_add_u32 m0, s57, 5120
    s_add_u32 s32, s59, 61056
    buffer_load_dwordx4 v152, s[8:11], s32 offen lds
    s_add_u32 m0, s57, 6144
    s_add_u32 s32, s59, 62208
    buffer_load_dwordx4 v152, s[8:11], s32 offen lds
    s_add_u32 m0, s57, 7168
    s_add_u32 s32, s59, 63360
    buffer_load_dwordx4 v152, s[8:11], s32 offen lds
    s_waitcnt vmcnt(0)
    v_mov_b32 v162, 0x8004
    ds_write_b16 v163, v162
    s_waitcnt vmcnt(0) lgkmcnt(0)
    s_endpgm
L_fallback:
    s_waitcnt vmcnt(0)
    s_mov_b32 s46, 1
    v_mov_b32 v160, v8
    v_mov_b32 v161, v9
    v_mov_b32 v10, v158
    v_mov_b32 v56, 0
    v_mov_b32 v57, 0
    v_mov_b32 v58, 0
    v_mov_b32 v59, 0
    v_mov_b32 v60, 0
    v_mov_b32 v61, 0
    v_mov_b32 v62, 0
    v_mov_b32 v63, 0
    v_mov_b32 v64, 0
    v_mov_b32 v65, 0
    v_mov_b32 v66, 0
    v_mov_b32 v67, 0
    v_mov_b32 v68, 0
    v_mov_b32 v69, 0
    v_mov_b32 v70, 0
    v_mov_b32 v71, 0
    v_mov_b32 v155, 0xff7fffff
    s_mov_b32 s47, 32
L_fb_loop:
    ds_read_b32 v22, v161
    ds_read_b128 v[24:27], v160
    ds_read_b128 v[28:31], v160 offset:1024
    ds_read_b128 v[32:35], v10 offset:0
    ds_read_b128 v[36:39], v10 offset:32
    ds_read_b128 v[40:43], v10 offset:64
    ds_read_b128 v[44:47], v10 offset:96
    s_waitcnt lgkmcnt(0)
    v_mfma_f32_32x32x4_2b_bf16 v[88:119], v[22:23], v[20:21], 0
    s_nop 15
    s_nop 3
    v_mfma_f32_32x32x16_bf16 v[88:103], v[24:27], v[16:19], v[88:103]
    v_mfma_f32_32x32x16_bf16 v[104:119], v[28:31], v[16:19], v[104:119]
    s_nop 15
    v_max3_f32 v156, v88, v89, v155
    v_max3_f32 v156, v90, v91, v156
    v_max3_f32 v156, v92, v93, v156
    v_max3_f32 v156, v94, v95, v156
    v_max3_f32 v156, v96, v97, v156
    v_max3_f32 v156, v98, v99, v156
    v_max3_f32 v156, v100, v101, v156
    v_max3_f32 v156, v102, v103, v156
    v_max3_f32 v156, v104, v105, v156
    v_max3_f32 v156, v106, v107, v156
    v_max3_f32 v156, v108, v109, v156
    v_max3_f32 v156, v110, v111, v156
    v_max3_f32 v156, v112, v113, v156
    v_max3_f32 v156, v114, v115, v156
    v_max3_f32 v156, v116, v117, v156
    v_max3_f32 v156, v118, v119, v156
    v_mov_b32 v157, v156
    s_nop 1
    v_permlane32_swap_b32 v156, v157
    s_nop 1
    v_max_f32 v156, v156, v157
    v_sub_f32 v157, v155, v156
    v_exp_f32 v157, v157
    v_mov_b32 v155, v156
    v_mul_f32 v56, v56, v157
    v_mul_f32 v57, v57, v157
    v_mul_f32 v58, v58, v157
    v_mul_f32 v59, v59, v157
    v_mul_f32 v60, v60, v157
    v_mul_f32 v61, v61, v157
    v_mul_f32 v62, v62, v157
    v_mul_f32 v63, v63, v157
    v_mul_f32 v64, v64, v157
    v_mul_f32 v65, v65, v157
    v_mul_f32 v66, v66, v157
    v_mul_f32 v67, v67, v157
    v_mul_f32 v68, v68, v157
    v_mul_f32 v69, v69, v157
    v_mul_f32 v70, v70, v157
    v_mul_f32 v71, v71, v157
    v_sub_f32 v88, v88, v155
    v_sub_f32 v89, v89, v155
    v_sub_f32 v90, v90, v155
    v_sub_f32 v91, v91, v155
    v_sub_f32 v92, v92, v155
    v_sub_f32 v93, v93, v155
    v_sub_f32 v94, v94, v155
    v_sub_f32 v95, v95, v155
    v_sub_f32 v96, v96, v155
    v_sub_f32 v97, v97, v155
    v_sub_f32 v98, v98, v155
    v_sub_f32 v99, v99, v155
    v_sub_f32 v100, v100, v155
    v_sub_f32 v101, v101, v155
    v_sub_f32 v102, v102, v155
    v_sub_f32 v103, v103, v155
    v_sub_f32 v104, v104, v155
    v_sub_f32 v105, v105, v155
    v_sub_f32 v106, v106, v155
    v_sub_f32 v107, v107, v155
    v_sub_f32 v108, v108, v155
    v_sub_f32 v109, v109, v155
    v_sub_f32 v110, v110, v155
    v_sub_f32 v111, v111, v155
    v_sub_f32 v112, v112, v155
    v_sub_f32 v113, v113, v155
    v_sub_f32 v114, v114, v155
    v_sub_f32 v115, v115, v155
    v_sub_f32 v116, v116, v155
    v_sub_f32 v117, v117, v155
    v_sub_f32 v118, v118, v155
    v_sub_f32 v119, v119, v155
    v_exp_f32 v88, v88
    v_exp_f32 v89, v89
    v_exp_f32 v90, v90
    v_exp_f32 v91, v91
    v_exp_f32 v92, v92
    v_exp_f32 v93, v93
    v_exp_f32 v94, v94
    v_exp_f32 v95, v95
    v_exp_f32 v96, v96
    v_exp_f32 v97, v97
    v_exp_f32 v98, v98
    v_exp_f32 v99, v99
    v_exp_f32 v100, v100
    v_exp_f32 v101, v101
    v_exp_f32 v102, v102
    v_exp_f32 v103, v103
    v_exp_f32 v104, v104
    v_exp_f32 v105, v105
    v_exp_f32 v106, v106
    v_exp_f32 v107, v107
    v_exp_f32 v108, v108
    v_exp_f32 v109, v109
    v_exp_f32 v110, v110
    v_exp_f32 v111, v111
    v_exp_f32 v112, v112
    v_exp_f32 v113, v113
    v_exp_f32 v114, v114
    v_exp_f32 v115, v115
    v_exp_f32 v116, v116
    v_exp_f32 v117, v117
    v_exp_f32 v118, v118
    v_exp_f32 v119, v119
    s_nop 0
    v_add_u32 v88, 0x8000, v88
    v_add_u32 v89, 0x8000, v89
    v_add_u32 v90, 0x8000, v90
    v_add_u32 v91, 0x8000, v91
    v_add_u32 v92, 0x8000, v92
    v_add_u32 v93, 0x8000, v93
    v_add_u32 v94, 0x8000, v94
    v_add_u32 v95, 0x8000, v95
    v_add_u32 v96, 0x8000, v96
    v_add_u32 v97, 0x8000, v97
    v_add_u32 v98, 0x8000, v98
    v_add_u32 v99, 0x8000, v99
    v_add_u32 v100, 0x8000, v100
    v_add_u32 v101, 0x8000, v101
    v_add_u32 v102, 0x8000, v102
    v_add_u32 v103, 0x8000, v103
    v_add_u32 v104, 0x8000, v104
    v_add_u32 v105, 0x8000, v105
    v_add_u32 v106, 0x8000, v106
    v_add_u32 v107, 0x8000, v107
    v_add_u32 v108, 0x8000, v108
    v_add_u32 v109, 0x8000, v109
    v_add_u32 v110, 0x8000, v110
    v_add_u32 v111, 0x8000, v111
    v_add_u32 v112, 0x8000, v112
    v_add_u32 v113, 0x8000, v113
    v_add_u32 v114, 0x8000, v114
    v_add_u32 v115, 0x8000, v115
    v_add_u32 v116, 0x8000, v116
    v_add_u32 v117, 0x8000, v117
    v_add_u32 v118, 0x8000, v118
    v_add_u32 v119, 0x8000, v119
    s_nop 1
    v_smfmac_f32_32x32x32_bf16 v[56:71], v[32:35], v[88:95], v48
    v_smfmac_f32_32x32x32_bf16 v[56:71], v[36:39], v[96:103], v48
    v_smfmac_f32_32x32x32_bf16 v[56:71], v[40:43], v[104:111], v48
    v_smfmac_f32_32x32x32_bf16 v[56:71], v[44:47], v[112:119], v48
    v_add_u32 v160, 0x800, v160
    v_add_u32 v161, 0x100, v161
    v_add_u32 v10, 0x80, v10
    s_nop 15
    s_sub_u32 s47, s47, 1
    s_cmp_lg_u32 s47, 0
    s_cbranch_scc1 L_fb_loop
    s_branch L_final

.section .rodata,"a"
.p2align 6
.amdhsa_kernel standalone__fused_io_aware_attn__prompt_kernel
  .amdhsa_next_free_vgpr 168
  .amdhsa_next_free_sgpr 96
  .amdhsa_accum_offset 168
  .amdhsa_group_segment_fixed_size 0
  .amdhsa_kernarg_size 48
  .amdhsa_user_sgpr_count 2
  .amdhsa_user_sgpr_kernarg_segment_ptr 1
  .amdhsa_system_sgpr_workgroup_id_x 1
  .amdhsa_float_denorm_mode_32 3
.end_amdhsa_kernel
```
